```python
import torch

def _softmax(x, axis=-1):
    return torch.softmax(x, dim=axis)
def _gelu(x):
    return torch.nn.functional.gelu(x, approximate="tanh")
def _silu(x):
    return torch.nn.functional.silu(x)
def _sigmoid(x):
    return torch.sigmoid(x)
def _layernorm(x, axis=-1, eps=1e-5):
    m = x.mean(dim=axis, keepdim=True)
    v = x.var(dim=axis, keepdim=True, unbiased=False)
    return (x - m) / torch.sqrt(v + eps)
def _scatter_add(tgt, idx, src, axis=0):
    return tgt.clone().index_add_(axis, idx, src)
def _segment_sum(src, seg, n):
    out = torch.zeros((n,) + src.shape[1:], dtype=src.dtype)
    return out.index_add_(0, seg, src)
def _pad(x, pw):
    flat = tuple(v for pair in reversed(pw) for v in pair)
    return torch.nn.functional.pad(x, flat)

kernel_name = 'parallel_sum__sliding_block_cached__mixer_channel_mlp__decode'

def setup_inputs():

    _w = (lambda a: (lambda t: t.to(torch.bfloat16) if t.is_floating_point() else t)(torch.as_tensor(a)))
    def _A_setup():
        B, Sq, D = 1, 1, 448
        Hq, Hkv, Sk, Dh = 16, 8, 32768, 256
        assert Hq % Hkv == 0, (Hq, Hkv)
        return {
            "x": _w((lambda *s: torch.randn(*s, dtype=torch.bfloat16) * 0.05)(B, Sq, D)),
            "k_cache": _w((lambda *s: torch.randn(*s, dtype=torch.bfloat16) * 3.2)(B, Hkv, Sk, Dh)),
            "v_cache": _w((lambda *s: torch.randn(*s, dtype=torch.bfloat16) * 0.4)(B, Hkv, Sk, Dh)),
            "wq": _w((lambda *s: torch.randn(*s, dtype=torch.bfloat16) * 3.2)(D, Hq * Dh) * (D ** -0.5)),
            "wo": _w((lambda *s: torch.randn(*s, dtype=torch.bfloat16) * 0.4)(Hq * Dh, D) * ((Hq * Dh) ** -0.5)),
        }
    _A_in = _A_setup()

    def _B_setup():
        B, S, D, F = 1, 1, 448, 1792
        return {
            "x": _w((lambda *s: torch.randn(*s, dtype=torch.bfloat16) * 0.05)(B, S, D)),
            "w1": _w((lambda *s: torch.randn(*s, dtype=torch.bfloat16) * 3.2)(D, F) * (D ** -0.5)),
            "b1": _w((lambda *s: torch.randn(*s, dtype=torch.bfloat16) * 1.6)(F)),
            "w2": _w((lambda *s: torch.randn(*s, dtype=torch.bfloat16) * 0.1)(F, D) * (F ** -0.5)),
            "b2": _w((lambda *s: torch.randn(*s, dtype=torch.bfloat16) * 0.1)(D)),
        }
    _B_in = _B_setup()

    return {
        "A_x": _A_in["x"],
        "A_k_cache": _A_in["k_cache"],
        "A_v_cache": _A_in["v_cache"],
        "A_wq": _A_in["wq"],
        "A_wo": _A_in["wo"],
        "B_x": _B_in["x"],
        "B_w1": _B_in["w1"],
        "B_b1": _B_in["b1"],
        "B_w2": _B_in["w2"],
        "B_b2": _B_in["b2"],
    }

def reference(A_x, A_k_cache, A_v_cache, A_wq, A_wo, B_x, B_w1, B_b1, B_w2, B_b2):
    def _A_ref(x, k_cache, v_cache, wq, wo):
        B, Sq, D = x.shape
        Hq, Dh = 16, 256
        Hkv, Sk = k_cache.shape[1], k_cache.shape[2]
        W = min(4096, max(256, Sk // 4))
        rep = Hq // Hkv
        q = (lambda x, *d: x.permute(*d))((x @ wq).reshape(B, Sq, Hq, Dh), 0, 2, 1, 3)
        k = (lambda x, n, axis: torch.repeat_interleave(x, n, dim=axis))(k_cache[:, :, Sk - W:, :], rep, axis=1)
        v = (lambda x, n, axis: torch.repeat_interleave(x, n, dim=axis))(v_cache[:, :, Sk - W:, :], rep, axis=1)
        scores = torch.einsum("bhqd,bhkd->bhqk", q, k) * (Dh ** -0.5)
        p = _softmax(scores, axis=-1)
        o = torch.einsum("bhqk,bhkd->bhqd", p, v)
        return (lambda x, *d: x.permute(*d))(o, 0, 2, 1, 3).reshape(B, Sq, Hq * Dh) @ wo

    def _B_ref(x, w1, b1, w2, b2):
        y = _layernorm(x, axis=-1)
        h = _gelu(torch.einsum("bsd,df->bsf", y, w1) + b1)
        return torch.einsum("bsf,fd->bsd", h, w2) + b2

    x = A_x
    xn = _layernorm(x, axis=-1)
    return x + _A_ref(xn, A_k_cache, A_v_cache, A_wq, A_wo) + _B_ref(xn, B_w1, B_b1, B_w2, B_b2)
```

```asm
; @launch grid=(256,1,1) block=(640,1,1) lds=19456
.amdgcn_target "amdgcn-amd-amdhsa--gfx950"
.text
.globl parallel_sum__sliding_block_cached__mixer_channel_mlp__decode_kernel
.p2align 8
.type parallel_sum__sliding_block_cached__mixer_channel_mlp__decode_kernel,@function
parallel_sum__sliding_block_cached__mixer_channel_mlp__decode_kernel:
    s_cmp_ge_u32 s2, 256
    s_cbranch_scc1 L_end
    s_load_dwordx16 s[16:31], s[0:1], 0
    s_load_dwordx8 s[32:39], s[0:1], 64
    s_load_dwordx2 s[40:41], s[0:1], 96
    v_lshrrev_b32 v1, 6, v0
    s_nop 0
    v_readfirstlane_b32 s3, v1
    v_and_b32 v1, 63, v0
    v_mov_b32 v3, 0
    s_lshr_b32 s66, s2, 5
    s_and_b32 s67, s2, 31
    s_lshl_b32 s77, s66, 5
    s_add_u32 s77, s77, s67
    s_mov_b32 s72, 0x05040100
    s_mov_b32 s73, 0x07060302
    s_mov_b32 s74, 0xffffffff
    s_mov_b32 s75, 0x00ffffff
    s_mov_b32 s76, 1069066811
    s_waitcnt lgkmcnt(0)
    s_mov_b32 s60, s40
    s_mov_b32 s61, s41
    s_mov_b32 s62, 6291456
    s_mov_b32 s63, 0x00020000
    s_cmp_eq_u32 s3, 0
    s_cbranch_scc1 L_control
    s_cmp_ge_u32 s3, 9
    s_cbranch_scc1 L_helper
    s_sub_u32 s69, s3, 1
    s_mov_b32 s44, s18
    s_mov_b32 s45, s19
    s_mov_b32 s46, 134217728
    s_mov_b32 s47, 0x00020000
    s_mov_b32 s48, s20
    s_mov_b32 s49, s21
    s_mov_b32 s50, 134217728
    s_mov_b32 s51, 0x00020000
    s_lshl_b32 s70, s66, 24
    s_lshl_b32 s8, s67, 16
    s_add_u32 s70, s70, s8
    s_lshl_b32 s8, s69, 13
    s_add_u32 s70, s70, s8
    s_add_u32 s70, s70, 14680064
    v_and_b32 v4, 15, v1
    v_lshlrev_b32 v4, 9, v4
    v_lshrrev_b32 v5, 4, v1
    v_lshl_add_u32 v4, v5, 4, v4
    v_lshrrev_b32 v5, 5, v1
    v_lshlrev_b32 v5, 12, v5
    v_and_b32 v6, 31, v1
    v_lshl_add_u32 v5, v6, 4, v5
    s_barrier
    buffer_load_dwordx4 v[32:35], v4, s[44:47], s70 offen offset:0 nt
    buffer_load_dwordx4 v[36:39], v4, s[44:47], s70 offen offset:64 nt
    buffer_load_dwordx4 v[40:43], v4, s[44:47], s70 offen offset:128 nt
    buffer_load_dwordx4 v[44:47], v4, s[44:47], s70 offen offset:192 nt
    buffer_load_dwordx4 v[48:51], v4, s[44:47], s70 offen offset:256 nt
    buffer_load_dwordx4 v[52:55], v4, s[44:47], s70 offen offset:320 nt
    buffer_load_dwordx4 v[56:59], v4, s[44:47], s70 offen offset:384 nt
    buffer_load_dwordx4 v[60:63], v4, s[44:47], s70 offen offset:448 nt
    buffer_load_dwordx4 v[64:67], v5, s[48:51], s70 offen offset:0 nt
    buffer_load_dwordx4 v[68:71], v5, s[48:51], s70 offen offset:512 nt
    buffer_load_dwordx4 v[72:75], v5, s[48:51], s70 offen offset:1024 nt
    buffer_load_dwordx4 v[76:79], v5, s[48:51], s70 offen offset:1536 nt
    buffer_load_dwordx4 v[80:83], v5, s[48:51], s70 offen offset:2048 nt
    buffer_load_dwordx4 v[84:87], v5, s[48:51], s70 offen offset:2560 nt
    buffer_load_dwordx4 v[88:91], v5, s[48:51], s70 offen offset:3072 nt
    buffer_load_dwordx4 v[92:95], v5, s[48:51], s70 offen offset:3584 nt
    v_and_b32 v6, 1, v1
    v_lshlrev_b32 v6, 9, v6
    v_lshrrev_b32 v7, 4, v1
    v_lshl_add_u32 v6, v7, 4, v6
    v_mov_b32 v15, 1
    s_mov_b32 s88, 0
L_sq:
    ds_read_b32 v7, v3 offset:1024
    s_waitcnt lgkmcnt(0)
    v_readfirstlane_b32 s89, v7
    s_cmp_ge_u32 s89, 1
    s_cbranch_scc1 L_sq_done
    s_add_u32 s88, s88, 1
    s_sleep 1
    s_cmp_lt_u32 s88, 800000
    s_cbranch_scc1 L_sq
L_sq_done:
    s_nop 1
    ds_read_b64 v[8:9], v3 offset:1040
    ds_read_b128 v[96:99], v6 offset:0
    ds_read_b128 v[100:103], v6 offset:64
    ds_read_b128 v[104:107], v6 offset:128
    ds_read_b128 v[108:111], v6 offset:192
    ds_read_b128 v[112:115], v6 offset:256
    ds_read_b128 v[116:119], v6 offset:320
    ds_read_b128 v[120:123], v6 offset:384
    ds_read_b128 v[124:127], v6 offset:448
    s_waitcnt vmcnt(8) lgkmcnt(0)
    v_readfirstlane_b32 s64, v8
    v_readfirstlane_b32 s65, v9
    v_mfma_f32_16x16x32_bf16 v[8:11], v[96:99], v[32:35], 0
    v_mfma_f32_16x16x32_bf16 v[8:11], v[100:103], v[36:39], v[8:11]
    v_mfma_f32_16x16x32_bf16 v[8:11], v[104:107], v[40:43], v[8:11]
    v_mfma_f32_16x16x32_bf16 v[8:11], v[108:111], v[44:47], v[8:11]
    v_mfma_f32_16x16x32_bf16 v[8:11], v[112:115], v[48:51], v[8:11]
    v_mfma_f32_16x16x32_bf16 v[8:11], v[116:119], v[52:55], v[8:11]
    v_mfma_f32_16x16x32_bf16 v[8:11], v[120:123], v[56:59], v[8:11]
    v_mfma_f32_16x16x32_bf16 v[8:11], v[124:127], v[60:63], v[8:11]
    s_nop 7
    v_cvt_pk_bf16_f32 v12, v8, v9
    v_and_b32 v14, 0xffff0000, v12
    v_lshlrev_b32 v13, 16, v12
    v_mul_f32 v13, 0x3d800000, v13
    v_mul_f32 v14, 0x3d800000, v14
    v_mov_b32 v16, v13
    v_mov_b32 v18, v14
    s_nop 0
    v_max_f32_dpp v16, v16, v16 row_ror:1 row_mask:0xf bank_mask:0xf
    v_max_f32_dpp v18, v18, v18 row_ror:1 row_mask:0xf bank_mask:0xf
    s_nop 0
    v_max_f32_dpp v16, v16, v16 row_ror:2 row_mask:0xf bank_mask:0xf
    v_max_f32_dpp v18, v18, v18 row_ror:2 row_mask:0xf bank_mask:0xf
    s_nop 0
    v_max_f32_dpp v16, v16, v16 row_ror:4 row_mask:0xf bank_mask:0xf
    v_max_f32_dpp v18, v18, v18 row_ror:4 row_mask:0xf bank_mask:0xf
    s_nop 0
    v_max_f32_dpp v16, v16, v16 row_ror:8 row_mask:0xf bank_mask:0xf
    v_max_f32_dpp v18, v18, v18 row_ror:8 row_mask:0xf bank_mask:0xf
    v_sub_f32 v13, v13, v16
    v_sub_f32 v14, v14, v18
    v_mul_f32 v13, s76, v13
    v_mul_f32 v14, s76, v14
    v_exp_f32 v13, v13
    v_exp_f32 v14, v14
    s_nop 0
    v_mov_b32_dpp v20, v13 quad_perm:[1,1,3,3] row_mask:0xf bank_mask:0xf
    v_mov_b32_dpp v21, v14 quad_perm:[1,1,3,3] row_mask:0xf bank_mask:0xf
    v_cvt_pk_bf16_f32 v20, v13, v20
    v_cvt_pk_bf16_f32 v21, v14, v21
    s_nop 0
    v_mov_b32_dpp v20, v20 row_ror:8 row_mask:0xc bank_mask:0xf
    v_mov_b32_dpp v21, v21 row_ror:8 row_mask:0xc bank_mask:0xf
    s_nop 0
    v_mov_b32_dpp v48, v20 row_newbcast:0 row_mask:0xf bank_mask:0xf
    v_mov_b32_dpp v52, v21 row_newbcast:0 row_mask:0xf bank_mask:0xf
    v_mov_b32_dpp v49, v20 row_newbcast:2 row_mask:0xf bank_mask:0xf
    v_mov_b32_dpp v53, v21 row_newbcast:2 row_mask:0xf bank_mask:0xf
    v_mov_b32_dpp v50, v20 row_newbcast:4 row_mask:0xf bank_mask:0xf
    v_mov_b32_dpp v54, v21 row_newbcast:4 row_mask:0xf bank_mask:0xf
    v_mov_b32_dpp v51, v20 row_newbcast:6 row_mask:0xf bank_mask:0xf
    v_mov_b32_dpp v55, v21 row_newbcast:6 row_mask:0xf bank_mask:0xf
    v_mov_b32 v17, v13
    v_mov_b32 v19, v14
    s_nop 0
    v_add_f32_dpp v17, v17, v17 row_ror:1 row_mask:0xf bank_mask:0xf
    v_add_f32_dpp v19, v19, v19 row_ror:1 row_mask:0xf bank_mask:0xf
    s_nop 0
    v_add_f32_dpp v17, v17, v17 row_ror:2 row_mask:0xf bank_mask:0xf
    v_add_f32_dpp v19, v19, v19 row_ror:2 row_mask:0xf bank_mask:0xf
    s_nop 0
    v_add_f32_dpp v17, v17, v17 row_ror:4 row_mask:0xf bank_mask:0xf
    v_add_f32_dpp v19, v19, v19 row_ror:4 row_mask:0xf bank_mask:0xf
    s_nop 0
    v_add_f32_dpp v17, v17, v17 row_ror:8 row_mask:0xf bank_mask:0xf
    v_add_f32_dpp v19, v19, v19 row_ror:8 row_mask:0xf bank_mask:0xf
    s_lshl_b32 s8, s69, 4
    v_mov_b32 v7, s8
    ds_write_b128 v7, v[16:19] offset:1152
    s_waitcnt vmcnt(6)
    v_perm_b32 v56, v68, v64, s72
    v_perm_b32 v57, v68, v64, s73
    v_dot2_f32_bf16 v32, v56, v48, 0
    v_dot2_f32_bf16 v40, v56, v52, 0
    v_dot2_f32_bf16 v33, v57, v48, 0
    v_dot2_f32_bf16 v41, v57, v52, 0
    v_perm_b32 v56, v69, v65, s72
    v_perm_b32 v57, v69, v65, s73
    v_dot2_f32_bf16 v34, v56, v48, 0
    v_dot2_f32_bf16 v42, v56, v52, 0
    v_dot2_f32_bf16 v35, v57, v48, 0
    v_dot2_f32_bf16 v43, v57, v52, 0
    v_perm_b32 v56, v70, v66, s72
    v_perm_b32 v57, v70, v66, s73
    v_dot2_f32_bf16 v36, v56, v48, 0
    v_dot2_f32_bf16 v44, v56, v52, 0
    v_dot2_f32_bf16 v37, v57, v48, 0
    v_dot2_f32_bf16 v45, v57, v52, 0
    v_perm_b32 v56, v71, v67, s72
    v_perm_b32 v57, v71, v67, s73
    v_dot2_f32_bf16 v38, v56, v48, 0
    v_dot2_f32_bf16 v46, v56, v52, 0
    v_dot2_f32_bf16 v39, v57, v48, 0
    v_dot2_f32_bf16 v47, v57, v52, 0
    s_waitcnt vmcnt(4)
    v_perm_b32 v56, v76, v72, s72
    v_perm_b32 v57, v76, v72, s73
    v_dot2_f32_bf16 v32, v56, v49, v32
    v_dot2_f32_bf16 v40, v56, v53, v40
    v_dot2_f32_bf16 v33, v57, v49, v33
    v_dot2_f32_bf16 v41, v57, v53, v41
    v_perm_b32 v56, v77, v73, s72
    v_perm_b32 v57, v77, v73, s73
    v_dot2_f32_bf16 v34, v56, v49, v34
    v_dot2_f32_bf16 v42, v56, v53, v42
    v_dot2_f32_bf16 v35, v57, v49, v35
    v_dot2_f32_bf16 v43, v57, v53, v43
    v_perm_b32 v56, v78, v74, s72
    v_perm_b32 v57, v78, v74, s73
    v_dot2_f32_bf16 v36, v56, v49, v36
    v_dot2_f32_bf16 v44, v56, v53, v44
    v_dot2_f32_bf16 v37, v57, v49, v37
    v_dot2_f32_bf16 v45, v57, v53, v45
    v_perm_b32 v56, v79, v75, s72
    v_perm_b32 v57, v79, v75, s73
    v_dot2_f32_bf16 v38, v56, v49, v38
    v_dot2_f32_bf16 v46, v56, v53, v46
    v_dot2_f32_bf16 v39, v57, v49, v39
    v_dot2_f32_bf16 v47, v57, v53, v47
    s_waitcnt vmcnt(2)
    v_perm_b32 v56, v84, v80, s72
    v_perm_b32 v57, v84, v80, s73
    v_dot2_f32_bf16 v32, v56, v50, v32
    v_dot2_f32_bf16 v40, v56, v54, v40
    v_dot2_f32_bf16 v33, v57, v50, v33
    v_dot2_f32_bf16 v41, v57, v54, v41
    v_perm_b32 v56, v85, v81, s72
    v_perm_b32 v57, v85, v81, s73
    v_dot2_f32_bf16 v34, v56, v50, v34
    v_dot2_f32_bf16 v42, v56, v54, v42
    v_dot2_f32_bf16 v35, v57, v50, v35
    v_dot2_f32_bf16 v43, v57, v54, v43
    v_perm_b32 v56, v86, v82, s72
    v_perm_b32 v57, v86, v82, s73
    v_dot2_f32_bf16 v36, v56, v50, v36
    v_dot2_f32_bf16 v44, v56, v54, v44
    v_dot2_f32_bf16 v37, v57, v50, v37
    v_dot2_f32_bf16 v45, v57, v54, v45
    v_perm_b32 v56, v87, v83, s72
    v_perm_b32 v57, v87, v83, s73
    v_dot2_f32_bf16 v38, v56, v50, v38
    v_dot2_f32_bf16 v46, v56, v54, v46
    v_dot2_f32_bf16 v39, v57, v50, v39
    v_dot2_f32_bf16 v47, v57, v54, v47
    s_waitcnt vmcnt(0)
    v_perm_b32 v56, v92, v88, s72
    v_perm_b32 v57, v92, v88, s73
    v_dot2_f32_bf16 v32, v56, v51, v32
    v_dot2_f32_bf16 v40, v56, v55, v40
    v_dot2_f32_bf16 v33, v57, v51, v33
    v_dot2_f32_bf16 v41, v57, v55, v41
    v_perm_b32 v56, v93, v89, s72
    v_perm_b32 v57, v93, v89, s73
    v_dot2_f32_bf16 v34, v56, v51, v34
    v_dot2_f32_bf16 v42, v56, v55, v42
    v_dot2_f32_bf16 v35, v57, v51, v35
    v_dot2_f32_bf16 v43, v57, v55, v43
    v_perm_b32 v56, v94, v90, s72
    v_perm_b32 v57, v94, v90, s73
    v_dot2_f32_bf16 v36, v56, v51, v36
    v_dot2_f32_bf16 v44, v56, v55, v44
    v_dot2_f32_bf16 v37, v57, v51, v37
    v_dot2_f32_bf16 v45, v57, v55, v45
    v_perm_b32 v56, v95, v91, s72
    v_perm_b32 v57, v95, v91, s73
    v_dot2_f32_bf16 v38, v56, v51, v38
    v_dot2_f32_bf16 v46, v56, v55, v46
    v_dot2_f32_bf16 v39, v57, v51, v39
    v_dot2_f32_bf16 v47, v57, v55, v47
    v_permlane32_swap_b32 v32, v40
    v_permlane32_swap_b32 v33, v41
    v_permlane32_swap_b32 v34, v42
    v_permlane32_swap_b32 v35, v43
    v_permlane32_swap_b32 v36, v44
    v_permlane32_swap_b32 v37, v45
    v_permlane32_swap_b32 v38, v46
    v_permlane32_swap_b32 v39, v47
    v_add_f32 v32, v32, v40
    v_add_f32 v33, v33, v41
    v_add_f32 v34, v34, v42
    v_add_f32 v35, v35, v43
    v_add_f32 v36, v36, v44
    v_add_f32 v37, v37, v45
    v_add_f32 v38, v38, v46
    v_add_f32 v39, v39, v47
    s_lshl_b32 s8, s69, 11
    v_lshlrev_b32 v6, 5, v1
    v_add_u32 v6, s8, v6
    ds_write_b128 v6, v[32:35] offset:2048
    ds_write_b128 v6, v[36:39] offset:2064
    v_lshlrev_b32 v6, 3, v1
    v_and_b32 v20, 15, v1
    v_lshlrev_b32 v20, 3, v20
    v_lshrrev_b32 v7, 3, v1
    v_lshlrev_b32 v7, 13, v7
    v_and_b32 v23, 7, v1
    v_lshl_add_u32 v7, v23, 4, v7
    v_lshlrev_b32 v23, 13, v1
    s_lshl_b32 s8, s66, 18
    s_lshl_b32 s9, s67, 8
    s_add_u32 s8, s8, s9
    s_add_u32 s8, s8, 262144
    s_add_u32 s9, s8, 65536
    s_add_u32 s10, s8, 131072
    s_add_u32 s11, s8, 196608
    s_waitcnt lgkmcnt(0)
    s_mov_b64 exec, 1
    ds_add_rtn_u32 v9, v3, v15 offset:1028
    s_mov_b64 exec, -1
    v_mov_b32 v34, s64
    v_mov_b32 v35, s65
    v_mov_b32 v38, s64
    v_mov_b32 v39, s65
    v_mov_b32 v42, s64
    v_mov_b32 v43, s65
    v_mov_b32 v46, s64
    v_mov_b32 v47, s65
    v_mov_b32 v50, s64
    v_mov_b32 v51, s65
    s_waitcnt lgkmcnt(0)
    v_readfirstlane_b32 s12, v9
    s_cmp_eq_u32 s12, 7
    s_cbranch_scc0 L_after_combine
    ds_read_b64 v[8:9], v20 offset:1152
    ds_read_b64 v[64:65], v6 offset:2048
    ds_read_b64 v[66:67], v6 offset:2560
    ds_read_b64 v[68:69], v6 offset:3072
    ds_read_b64 v[70:71], v6 offset:3584
    ds_read_b64 v[72:73], v6 offset:4096
    ds_read_b64 v[74:75], v6 offset:4608
    s_waitcnt lgkmcnt(6)
    v_mov_b32 v10, v8
    s_nop 1
    v_max_f32_dpp v10, v10, v10 row_ror:2 row_mask:0xf bank_mask:0xf
    s_nop 1
    v_max_f32_dpp v10, v10, v10 row_ror:4 row_mask:0xf bank_mask:0xf
    s_nop 1
    v_max_f32_dpp v10, v10, v10 row_ror:8 row_mask:0xf bank_mask:0xf
    v_sub_f32 v11, v8, v10
    v_mul_f32 v11, s76, v11
    v_exp_f32 v11, v11
    s_nop 0
    v_mul_f32 v12, v11, v9
    s_nop 1
    v_add_f32_dpp v12, v12, v12 row_ror:2 row_mask:0xf bank_mask:0xf
    s_nop 1
    v_add_f32_dpp v12, v12, v12 row_ror:4 row_mask:0xf bank_mask:0xf
    s_nop 1
    v_add_f32_dpp v12, v12, v12 row_ror:8 row_mask:0xf bank_mask:0xf
    v_readlane_b32 s80, v11, 0
    v_readlane_b32 s81, v11, 1
    v_readlane_b32 s82, v11, 2
    v_readlane_b32 s83, v11, 3
    v_readlane_b32 s84, v11, 4
    v_readlane_b32 s85, v11, 5
    v_readlane_b32 s86, v11, 6
    v_readlane_b32 s87, v11, 7
    v_readlane_b32 s88, v11, 8
    v_readlane_b32 s89, v11, 9
    v_readlane_b32 s90, v11, 10
    v_readlane_b32 s91, v11, 11
    v_readlane_b32 s92, v11, 12
    v_readlane_b32 s93, v11, 13
    v_readlane_b32 s94, v11, 14
    v_readlane_b32 s95, v11, 15
    v_mov_b32_dpp v48, v10 row_newbcast:0 row_mask:0x1 bank_mask:0xf
    v_mov_b32_dpp v49, v12 row_newbcast:0 row_mask:0x1 bank_mask:0xf
    s_nop 0
    v_mov_b32_dpp v48, v10 row_newbcast:1 row_mask:0x2 bank_mask:0xf
    v_mov_b32_dpp v49, v12 row_newbcast:1 row_mask:0x2 bank_mask:0xf
    ds_read_b64 v[76:77], v6 offset:5120
    ds_read_b64 v[78:79], v6 offset:5632
    ds_read_b64 v[80:81], v6 offset:6144
    ds_read_b64 v[82:83], v6 offset:6656
    ds_read_b64 v[84:85], v6 offset:7168
    ds_read_b64 v[86:87], v6 offset:7680
    ds_read_b64 v[88:89], v6 offset:8192
    ds_read_b64 v[90:91], v6 offset:8704
    ds_read_b64 v[92:93], v6 offset:9216
    ds_read_b64 v[94:95], v6 offset:9728
    ds_read_b64 v[96:97], v6 offset:10240
    ds_read_b64 v[98:99], v6 offset:10752
    ds_read_b64 v[100:101], v6 offset:11264
    ds_read_b64 v[102:103], v6 offset:11776
    ds_read_b64 v[104:105], v6 offset:12288
    ds_read_b64 v[106:107], v6 offset:12800
    ds_read_b64 v[108:109], v6 offset:13312
    ds_read_b64 v[110:111], v6 offset:13824
    ds_read_b64 v[112:113], v6 offset:14336
    ds_read_b64 v[114:115], v6 offset:14848
    ds_read_b64 v[116:117], v6 offset:15360
    ds_read_b64 v[118:119], v6 offset:15872
    ds_read_b64 v[120:121], v6 offset:16384
    ds_read_b64 v[122:123], v6 offset:16896
    ds_read_b64 v[124:125], v6 offset:17408
    ds_read_b64 v[126:127], v6 offset:17920
    s_waitcnt lgkmcnt(15)
    v_mul_f32 v32, s80, v64
    v_mul_f32 v33, s80, v65
    v_mul_f32 v36, s80, v66
    v_mul_f32 v37, s80, v67
    v_mul_f32 v40, s81, v68
    v_mul_f32 v41, s81, v69
    v_mul_f32 v44, s81, v70
    v_mul_f32 v45, s81, v71
    v_fmac_f32 v32, s82, v72
    v_fmac_f32 v33, s82, v73
    v_fmac_f32 v36, s82, v74
    v_fmac_f32 v37, s82, v75
    v_fmac_f32 v40, s83, v76
    v_fmac_f32 v41, s83, v77
    v_fmac_f32 v44, s83, v78
    v_fmac_f32 v45, s83, v79
    v_fmac_f32 v32, s84, v80
    v_fmac_f32 v33, s84, v81
    v_fmac_f32 v36, s84, v82
    v_fmac_f32 v37, s84, v83
    v_fmac_f32 v40, s85, v84
    v_fmac_f32 v41, s85, v85
    v_fmac_f32 v44, s85, v86
    v_fmac_f32 v45, s85, v87
    v_fmac_f32 v32, s86, v88
    v_fmac_f32 v33, s86, v89
    v_fmac_f32 v36, s86, v90
    v_fmac_f32 v37, s86, v91
    v_fmac_f32 v40, s87, v92
    v_fmac_f32 v41, s87, v93
    v_fmac_f32 v44, s87, v94
    v_fmac_f32 v45, s87, v95
    s_waitcnt lgkmcnt(12)
    v_fmac_f32 v32, s88, v96
    v_fmac_f32 v33, s88, v97
    v_fmac_f32 v36, s88, v98
    v_fmac_f32 v37, s88, v99
    v_fmac_f32 v40, s89, v100
    v_fmac_f32 v41, s89, v101
    v_fmac_f32 v44, s89, v102
    v_fmac_f32 v45, s89, v103
    s_waitcnt lgkmcnt(8)
    v_fmac_f32 v32, s90, v104
    v_fmac_f32 v33, s90, v105
    v_fmac_f32 v36, s90, v106
    v_fmac_f32 v37, s90, v107
    v_fmac_f32 v40, s91, v108
    v_fmac_f32 v41, s91, v109
    v_fmac_f32 v44, s91, v110
    v_fmac_f32 v45, s91, v111
    s_waitcnt lgkmcnt(4)
    v_fmac_f32 v32, s92, v112
    v_fmac_f32 v33, s92, v113
    v_fmac_f32 v36, s92, v114
    v_fmac_f32 v37, s92, v115
    v_fmac_f32 v40, s93, v116
    v_fmac_f32 v41, s93, v117
    v_fmac_f32 v44, s93, v118
    v_fmac_f32 v45, s93, v119
    s_waitcnt lgkmcnt(0)
    v_fmac_f32 v32, s94, v120
    v_fmac_f32 v33, s94, v121
    v_fmac_f32 v36, s94, v122
    v_fmac_f32 v37, s94, v123
    v_fmac_f32 v40, s95, v124
    v_fmac_f32 v41, s95, v125
    v_fmac_f32 v44, s95, v126
    v_fmac_f32 v45, s95, v127
    s_mov_b32 s4, 0x00010001
    s_mov_b32 s5, 0
    buffer_store_dwordx4 v[32:35], v7, s[60:63], s8 offen sc1
    buffer_store_dwordx4 v[36:39], v7, s[60:63], s9 offen sc1
    buffer_store_dwordx4 v[40:43], v7, s[60:63], s10 offen sc1
    buffer_store_dwordx4 v[44:47], v7, s[60:63], s11 offen sc1
    s_mov_b64 exec, s[4:5]
    buffer_store_dwordx4 v[48:51], v23, s[60:63], s8 offen offset:128 sc1
    s_mov_b64 exec, 1
    ds_add_u32 v3, v15 offset:1028
    s_mov_b64 exec, -1
L_after_combine:
    s_nop 1
    s_cmp_lt_u32 s2, 228
    s_cbranch_scc1 L_end
    s_sub_u32 s8, s2, 228
    s_and_b32 s9, s8, 3
    s_lshr_b32 s8, s8, 2
    s_mov_b32 s44, s16
    s_mov_b32 s45, s17
    s_mov_b32 s46, 896
    s_mov_b32 s47, 0x00020000
    s_mov_b32 s48, s34
    s_mov_b32 s49, s35
    s_mov_b32 s50, 896
    s_mov_b32 s51, 0x00020000
    s_mov_b32 s52, s36
    s_mov_b32 s53, s37
    s_mov_b32 s54, 896
    s_mov_b32 s55, 0x00020000
    v_and_b32 v4, 7, v1
    v_lshlrev_b32 v5, 4, v4
    s_lshl_b32 s10, s8, 7
    s_lshl_b32 s11, s9, 2
    s_add_u32 s71, s10, s11
    buffer_load_dword v28, v5, s[44:47], s71 offen
    buffer_load_dword v29, v5, s[48:51], s71 offen
    s_mul_i32 s11, s9, 896
    s_add_u32 s10, s10, s11
    s_add_u32 s10, s10, 2359296
    s_mul_i32 s11, s69, 114688
    s_add_u32 s11, s11, s10
    s_mul_i32 s12, s69, 50176
    s_add_u32 s12, s12, s10
    s_add_u32 s12, s12, 917504
    s_add_u32 s13, s12, 28672
    s_add_u32 s14, s11, 28672
    s_add_u32 s15, s11, 57344
    s_add_u32 s70, s11, 86016
    v_lshrrev_b32 v6, 3, v1
    v_mul_u32_u24 v6, 3584, v6
    v_add_u32 v6, v6, v5
    s_mov_b32 s6, 0xffffffff
    s_mov_b32 s7, 0x0000ffff
    s_lshl_b32 s8, s69, 7
    v_add_u32 v7, s8, v5
    s_mov_b32 s88, 0
L_f3:
    ds_read_b32 v8, v3 offset:1032
    s_waitcnt lgkmcnt(0)
    v_readfirstlane_b32 s89, v8
    s_cmp_ge_u32 s89, 1
    s_cbranch_scc1 L_f3_done
    s_add_u32 s88, s88, 1
    s_sleep 1
    s_cmp_lt_u32 s88, 800000
    s_cbranch_scc1 L_f3
L_f3_done:
    s_nop 1
    s_sleep 16
    buffer_load_dwordx4 v[32:35], v6, s[60:63], s11 offen sc1
    buffer_load_dwordx4 v[36:39], v6, s[60:63], s14 offen sc1
    buffer_load_dwordx4 v[40:43], v6, s[60:63], s15 offen sc1
    buffer_load_dwordx4 v[44:47], v6, s[60:63], s70 offen sc1
    buffer_load_dwordx4 v[48:51], v6, s[60:63], s12 offen sc1
    s_mov_b64 exec, s[6:7]
    buffer_load_dwordx4 v[52:55], v6, s[60:63], s13 offen sc1
    s_mov_b64 exec, -1
    s_sleep 8
    buffer_load_dwordx4 v[56:59], v6, s[60:63], s11 offen sc1
    buffer_load_dwordx4 v[60:63], v6, s[60:63], s14 offen sc1
    buffer_load_dwordx4 v[64:67], v6, s[60:63], s15 offen sc1
    buffer_load_dwordx4 v[68:71], v6, s[60:63], s70 offen sc1
    buffer_load_dwordx4 v[72:75], v6, s[60:63], s12 offen sc1
    s_mov_b64 exec, s[6:7]
    buffer_load_dwordx4 v[76:79], v6, s[60:63], s13 offen sc1
    s_mov_b64 exec, -1
    s_mov_b32 s88, 0
L_g3:
    s_nop 1
    s_waitcnt vmcnt(6)
    v_cmp_ne_u64 vcc, s[64:65], v[34:35]
    s_mov_b64 s[4:5], vcc
    v_cmp_ne_u64 vcc, s[64:65], v[38:39]
    s_or_b64 s[4:5], s[4:5], vcc
    v_cmp_ne_u64 vcc, s[64:65], v[42:43]
    s_or_b64 s[4:5], s[4:5], vcc
    v_cmp_ne_u64 vcc, s[64:65], v[46:47]
    s_or_b64 s[4:5], s[4:5], vcc
    v_cmp_ne_u64 vcc, s[64:65], v[50:51]
    s_or_b64 s[4:5], s[4:5], vcc
    v_cmp_ne_u64 vcc, s[64:65], v[54:55]
    s_and_b64 vcc, vcc, s[6:7]
    s_or_b64 s[4:5], s[4:5], vcc
    s_cmp_eq_u64 s[4:5], 0
    s_cbranch_scc1 L_g3_ok0
    buffer_load_dwordx4 v[32:35], v6, s[60:63], s11 offen sc1
    buffer_load_dwordx4 v[36:39], v6, s[60:63], s14 offen sc1
    buffer_load_dwordx4 v[40:43], v6, s[60:63], s15 offen sc1
    buffer_load_dwordx4 v[44:47], v6, s[60:63], s70 offen sc1
    buffer_load_dwordx4 v[48:51], v6, s[60:63], s12 offen sc1
    s_mov_b64 exec, s[6:7]
    buffer_load_dwordx4 v[52:55], v6, s[60:63], s13 offen sc1
    s_mov_b64 exec, -1
    s_waitcnt vmcnt(6)
    v_cmp_ne_u64 vcc, s[64:65], v[58:59]
    s_mov_b64 s[4:5], vcc
    v_cmp_ne_u64 vcc, s[64:65], v[62:63]
    s_or_b64 s[4:5], s[4:5], vcc
    v_cmp_ne_u64 vcc, s[64:65], v[66:67]
    s_or_b64 s[4:5], s[4:5], vcc
    v_cmp_ne_u64 vcc, s[64:65], v[70:71]
    s_or_b64 s[4:5], s[4:5], vcc
    v_cmp_ne_u64 vcc, s[64:65], v[74:75]
    s_or_b64 s[4:5], s[4:5], vcc
    v_cmp_ne_u64 vcc, s[64:65], v[78:79]
    s_and_b64 vcc, vcc, s[6:7]
    s_or_b64 s[4:5], s[4:5], vcc
    s_cmp_eq_u64 s[4:5], 0
    s_cbranch_scc1 L_g3_ok1
    buffer_load_dwordx4 v[56:59], v6, s[60:63], s11 offen sc1
    buffer_load_dwordx4 v[60:63], v6, s[60:63], s14 offen sc1
    buffer_load_dwordx4 v[64:67], v6, s[60:63], s15 offen sc1
    buffer_load_dwordx4 v[68:71], v6, s[60:63], s70 offen sc1
    buffer_load_dwordx4 v[72:75], v6, s[60:63], s12 offen sc1
    s_mov_b64 exec, s[6:7]
    buffer_load_dwordx4 v[76:79], v6, s[60:63], s13 offen sc1
    s_mov_b64 exec, -1
    s_add_u32 s88, s88, 1
    s_cmp_lt_u32 s88, 20000
    s_cbranch_scc1 L_g3
L_g3_ok0:
    s_nop 1
    v_add_f32 v8, v32, v36
    v_add_f32 v12, v40, v44
    v_cndmask_b32 v10, 0, v52, s[6:7]
    v_add_f32 v10, v10, v48
    v_add_f32 v8, v8, v12
    v_add_f32 v9, v33, v37
    v_add_f32 v13, v41, v45
    v_cndmask_b32 v11, 0, v53, s[6:7]
    v_add_f32 v11, v11, v49
    v_add_f32 v9, v9, v13
    s_branch L_g3_done
L_g3_ok1:
    s_nop 1
    v_add_f32 v8, v56, v60
    v_add_f32 v12, v64, v68
    v_cndmask_b32 v10, 0, v76, s[6:7]
    v_add_f32 v10, v10, v72
    v_add_f32 v8, v8, v12
    v_add_f32 v9, v57, v61
    v_add_f32 v13, v65, v69
    v_cndmask_b32 v11, 0, v77, s[6:7]
    v_add_f32 v11, v11, v73
    v_add_f32 v9, v9, v13
L_g3_done:
    s_nop 1
    v_add_f32_dpp v8, v8, v8 row_ror:8 row_mask:0xf bank_mask:0xf
    v_add_f32_dpp v9, v9, v9 row_ror:8 row_mask:0xf bank_mask:0xf
    v_add_f32_dpp v10, v10, v10 row_ror:8 row_mask:0xf bank_mask:0xf
    v_add_f32_dpp v11, v11, v11 row_ror:8 row_mask:0xf bank_mask:0xf
    v_mov_b32 v12, v8
    v_mov_b32 v13, v9
    v_mov_b32 v14, v10
    v_mov_b32 v16, v11
    v_permlane16_swap_b32 v12, v8
    v_permlane16_swap_b32 v13, v9
    v_permlane16_swap_b32 v14, v10
    v_permlane16_swap_b32 v16, v11
    v_add_f32 v8, v8, v12
    v_add_f32 v9, v9, v13
    v_add_f32 v10, v10, v14
    v_add_f32 v11, v11, v16
    v_mov_b32 v12, v8
    v_mov_b32 v13, v9
    v_mov_b32 v14, v10
    v_mov_b32 v16, v11
    v_permlane32_swap_b32 v12, v8
    v_permlane32_swap_b32 v13, v9
    v_permlane32_swap_b32 v14, v10
    v_permlane32_swap_b32 v16, v11
    v_add_f32 v8, v8, v12
    v_add_f32 v9, v9, v13
    v_add_f32 v10, v10, v14
    v_add_f32 v11, v11, v16
    ds_write_b128 v7, v[8:11] offset:18432
    s_waitcnt lgkmcnt(0)
    s_mov_b64 exec, 1
    ds_add_rtn_u32 v13, v3, v15 offset:1036
    s_mov_b64 exec, -1
    v_and_b32 v17, 0xffff0000, v28
    v_lshlrev_b32 v16, 16, v28
    v_and_b32 v19, 0xffff0000, v29
    v_lshlrev_b32 v18, 16, v29
    s_waitcnt lgkmcnt(0)
    v_readfirstlane_b32 s8, v13
    s_cmp_eq_u32 s8, 7
    s_cbranch_scc0 L_end
    ds_read_b128 v[96:99], v5 offset:18432
    ds_read_b128 v[100:103], v5 offset:18560
    ds_read_b128 v[104:107], v5 offset:18688
    ds_read_b128 v[108:111], v5 offset:18816
    ds_read_b128 v[112:115], v5 offset:18944
    ds_read_b128 v[116:119], v5 offset:19072
    ds_read_b128 v[120:123], v5 offset:19200
    ds_read_b128 v[124:127], v5 offset:19328
    s_waitcnt lgkmcnt(0)
    v_add_f32 v96, v96, v100
    v_add_f32 v97, v97, v101
    v_add_f32 v98, v98, v102
    v_add_f32 v99, v99, v103
    v_add_f32 v104, v104, v108
    v_add_f32 v105, v105, v109
    v_add_f32 v106, v106, v110
    v_add_f32 v107, v107, v111
    v_add_f32 v112, v112, v116
    v_add_f32 v113, v113, v117
    v_add_f32 v114, v114, v118
    v_add_f32 v115, v115, v119
    v_add_f32 v120, v120, v124
    v_add_f32 v121, v121, v125
    v_add_f32 v122, v122, v126
    v_add_f32 v123, v123, v127
    v_add_f32 v96, v96, v104
    v_add_f32 v97, v97, v105
    v_add_f32 v98, v98, v106
    v_add_f32 v99, v99, v107
    v_add_f32 v112, v112, v120
    v_add_f32 v113, v113, v121
    v_add_f32 v114, v114, v122
    v_add_f32 v115, v115, v123
    v_add_f32 v8, v96, v112
    v_add_f32 v9, v97, v113
    v_add_f32 v10, v98, v114
    v_add_f32 v11, v99, v115
    v_cvt_pk_bf16_f32 v8, v8, v8
    v_lshlrev_b32 v8, 16, v8
    v_cvt_pk_bf16_f32 v10, v10, v10
    v_lshlrev_b32 v10, 16, v10
    v_add_f32 v10, v10, v18
    v_cvt_pk_bf16_f32 v10, v10, v10
    v_lshlrev_b32 v10, 16, v10
    v_add_f32 v8, v16, v8
    v_cvt_pk_bf16_f32 v8, v8, v8
    v_lshlrev_b32 v8, 16, v8
    v_add_f32 v8, v8, v10
    v_cvt_pk_bf16_f32 v9, v9, v9
    v_lshlrev_b32 v9, 16, v9
    v_cvt_pk_bf16_f32 v11, v11, v11
    v_lshlrev_b32 v11, 16, v11
    v_add_f32 v11, v11, v19
    v_cvt_pk_bf16_f32 v11, v11, v11
    v_lshlrev_b32 v11, 16, v11
    v_add_f32 v9, v17, v9
    v_cvt_pk_bf16_f32 v9, v9, v9
    v_lshlrev_b32 v9, 16, v9
    v_add_f32 v9, v9, v11
    v_cvt_pk_bf16_f32 v8, v8, v9
    s_mov_b64 exec, 0xff
    buffer_store_dword v8, v5, s[52:55], s71 offen
    s_cmp_lg_u32 s2, 228
    s_cbranch_scc1 L_fin_end
    s_mov_b64 exec, 1
    v_mov_b32 v9, s64
    s_mov_b32 s93, 3928064
    buffer_store_dword v9, v3, s[60:63], s93 offen sc1
L_fin_end:
    s_branch L_end
L_control:
    s_nop 1
    s_setprio 3
    s_mov_b32 s93, 3928064
    s_load_dword s68, s[40:41], s93
    s_mov_b32 s44, s16
    s_mov_b32 s45, s17
    s_mov_b32 s46, 896
    s_mov_b32 s47, 0x00020000
    s_mov_b32 s48, s22
    s_mov_b32 s49, s23
    s_mov_b32 s50, 3670016
    s_mov_b32 s51, 0x00020000
    s_mov_b32 s52, s24
    s_mov_b32 s53, s25
    s_mov_b32 s54, 3670016
    s_mov_b32 s55, 0x00020000
    v_lshlrev_b32 v2, 4, v1
    buffer_load_dwordx4 v[4:7], v2, s[44:47], 0 offen
    v_lshrrev_b32 v15, 1, v1
    v_mul_u32_u24 v80, 28, v15
    buffer_load_dwordx4 v[8:11], v80, s[44:47], 0 offen
    buffer_load_dwordx3 v[12:14], v80, s[44:47], 0 offen offset:16
    s_and_b32 s8, s67, 7
    s_lshl_b32 s8, s8, 2
    s_lshr_b32 s9, s67, 3
    s_add_u32 s8, s8, s9
    v_mul_u32_u24 v80, 114688, v15
    v_and_b32 v81, 1, v1
    v_lshl_add_u32 v80, v81, 4, v80
    s_lshl_b32 s10, s66, 10
    s_lshl_b32 s11, s8, 5
    s_add_u32 s10, s10, s11
    buffer_load_dwordx4 v[16:19], v80, s[48:51], s10 offen nt
    s_add_u32 s10, s10, 8192
    buffer_load_dwordx4 v[20:23], v80, s[48:51], s10 offen nt
    s_add_u32 s10, s10, 8192
    buffer_load_dwordx4 v[24:27], v80, s[48:51], s10 offen nt
    s_add_u32 s10, s10, 8192
    buffer_load_dwordx4 v[28:31], v80, s[48:51], s10 offen nt
    s_add_u32 s10, s10, 8192
    buffer_load_dwordx4 v[32:35], v80, s[48:51], s10 offen nt
    s_add_u32 s10, s10, 8192
    buffer_load_dwordx4 v[36:39], v80, s[48:51], s10 offen nt
    s_add_u32 s10, s10, 8192
    buffer_load_dwordx4 v[40:43], v80, s[48:51], s10 offen nt
    s_add_u32 s10, s10, 8192
    buffer_load_dwordx4 v[44:47], v80, s[48:51], s10 offen nt
    s_add_u32 s10, s10, 8192
    buffer_load_dwordx4 v[48:51], v80, s[48:51], s10 offen nt
    s_add_u32 s10, s10, 8192
    buffer_load_dwordx4 v[52:55], v80, s[48:51], s10 offen nt
    s_add_u32 s10, s10, 8192
    buffer_load_dwordx4 v[56:59], v80, s[48:51], s10 offen nt
    s_add_u32 s10, s10, 8192
    buffer_load_dwordx4 v[60:63], v80, s[48:51], s10 offen nt
    s_add_u32 s10, s10, 8192
    buffer_load_dwordx4 v[64:67], v80, s[48:51], s10 offen nt
    s_add_u32 s10, s10, 8192
    buffer_load_dwordx4 v[68:71], v80, s[48:51], s10 offen nt
    v_mov_b32 v84, 0
    v_mov_b32 v85, 0
    v_mov_b32 v86, 0
    v_mov_b32 v87, 0
    ds_write_b128 v3, v[84:87] offset:1024
    s_waitcnt lgkmcnt(0)
    s_barrier
    s_waitcnt lgkmcnt(0)
    s_add_u32 s64, s68, 1
    s_mul_i32 s65, s64, 0x9E3779B1
    s_xor_b32 s65, s65, 0x85EBCA6B
    s_waitcnt vmcnt(14)
    v_and_b32 v81, 0xffff0000, v4
    v_lshlrev_b32 v80, 16, v4
    v_and_b32 v83, 0xffff0000, v5
    v_lshlrev_b32 v82, 16, v5
    v_and_b32 v85, 0xffff0000, v6
    v_lshlrev_b32 v84, 16, v6
    v_and_b32 v87, 0xffff0000, v7
    v_lshlrev_b32 v86, 16, v7
    v_add_f32 v88, v80, v81
    v_add_f32 v89, v82, v83
    v_add_f32 v90, v84, v85
    v_add_f32 v91, v86, v87
    v_add_f32 v88, v88, v89
    v_add_f32 v90, v90, v91
    v_add_f32 v88, v88, v90
    s_nop 1
    v_add_f32_dpp v88, v88, v88 row_ror:1 row_mask:0xf bank_mask:0xf
    s_nop 1
    v_add_f32_dpp v88, v88, v88 row_ror:2 row_mask:0xf bank_mask:0xf
    s_nop 1
    v_add_f32_dpp v88, v88, v88 row_ror:4 row_mask:0xf bank_mask:0xf
    s_nop 1
    v_add_f32_dpp v88, v88, v88 row_ror:8 row_mask:0xf bank_mask:0xf
    v_mov_b32 v89, v88
    s_nop 1
    v_permlane16_swap_b32 v89, v88
    v_add_f32 v88, v88, v89
    v_mov_b32 v89, v88
    s_nop 1
    v_permlane32_swap_b32 v89, v88
    v_add_f32 v88, v88, v89
    v_mul_f32 v88, 0x3b124925, v88
    v_mov_b32 v89, 0
    v_sub_f32 v90, v80, v88
    v_fmac_f32 v89, v90, v90
    v_sub_f32 v90, v81, v88
    v_fmac_f32 v89, v90, v90
    v_sub_f32 v90, v82, v88
    v_fmac_f32 v89, v90, v90
    v_sub_f32 v90, v83, v88
    v_fmac_f32 v89, v90, v90
    v_sub_f32 v90, v84, v88
    v_fmac_f32 v89, v90, v90
    v_sub_f32 v90, v85, v88
    v_fmac_f32 v89, v90, v90
    v_sub_f32 v90, v86, v88
    v_fmac_f32 v89, v90, v90
    v_sub_f32 v90, v87, v88
    v_fmac_f32 v89, v90, v90
    v_cndmask_b32 v89, 0, v89, s[74:75]
    s_nop 1
    v_add_f32_dpp v89, v89, v89 row_ror:1 row_mask:0xf bank_mask:0xf
    s_nop 1
    v_add_f32_dpp v89, v89, v89 row_ror:2 row_mask:0xf bank_mask:0xf
    s_nop 1
    v_add_f32_dpp v89, v89, v89 row_ror:4 row_mask:0xf bank_mask:0xf
    s_nop 1
    v_add_f32_dpp v89, v89, v89 row_ror:8 row_mask:0xf bank_mask:0xf
    v_mov_b32 v90, v89
    s_nop 1
    v_permlane16_swap_b32 v90, v89
    v_add_f32 v89, v89, v90
    v_mov_b32 v90, v89
    s_nop 1
    v_permlane32_swap_b32 v90, v89
    v_add_f32 v89, v89, v90
    v_mul_f32 v89, 0x3b124925, v89
    v_cvt_pk_bf16_f32 v100, v88, v88
    v_lshlrev_b32 v100, 16, v100
    v_cvt_pk_bf16_f32 v89, v89, v89
    v_lshlrev_b32 v89, 16, v89
    v_add_f32 v89, 0x3727c5ac, v89
    v_cvt_pk_bf16_f32 v89, v89, v89
    v_lshlrev_b32 v89, 16, v89
    v_sqrt_f32 v89, v89
    s_nop 0
    v_cvt_pk_bf16_f32 v101, v89, v89
    v_lshlrev_b32 v101, 16, v101
    v_rcp_f32 v102, v101
    v_and_b32 v89, 0xffff0000, v8
    v_lshlrev_b32 v88, 16, v8
    v_sub_f32 v92, v88, v100
    v_cvt_pk_bf16_f32 v92, v92, v92
    v_lshlrev_b32 v92, 16, v92
    v_mul_f32 v90, v92, v102
    v_fma_f32 v93, -v90, v101, v92
    v_fmac_f32 v90, v93, v102
    v_sub_f32 v92, v89, v100
    v_cvt_pk_bf16_f32 v92, v92, v92
    v_lshlrev_b32 v92, 16, v92
    v_mul_f32 v91, v92, v102
    v_fma_f32 v93, -v91, v101, v92
    v_fmac_f32 v91, v93, v102
    v_cvt_pk_bf16_f32 v104, v90, v91
    v_and_b32 v89, 0xffff0000, v9
    v_lshlrev_b32 v88, 16, v9
    v_sub_f32 v92, v88, v100
    v_cvt_pk_bf16_f32 v92, v92, v92
    v_lshlrev_b32 v92, 16, v92
    v_mul_f32 v90, v92, v102
    v_fma_f32 v93, -v90, v101, v92
    v_fmac_f32 v90, v93, v102
    v_sub_f32 v92, v89, v100
    v_cvt_pk_bf16_f32 v92, v92, v92
    v_lshlrev_b32 v92, 16, v92
    v_mul_f32 v91, v92, v102
    v_fma_f32 v93, -v91, v101, v92
    v_fmac_f32 v91, v93, v102
    v_cvt_pk_bf16_f32 v105, v90, v91
    v_and_b32 v89, 0xffff0000, v10
    v_lshlrev_b32 v88, 16, v10
    v_sub_f32 v92, v88, v100
    v_cvt_pk_bf16_f32 v92, v92, v92
    v_lshlrev_b32 v92, 16, v92
    v_mul_f32 v90, v92, v102
    v_fma_f32 v93, -v90, v101, v92
    v_fmac_f32 v90, v93, v102
    v_sub_f32 v92, v89, v100
    v_cvt_pk_bf16_f32 v92, v92, v92
    v_lshlrev_b32 v92, 16, v92
    v_mul_f32 v91, v92, v102
    v_fma_f32 v93, -v91, v101, v92
    v_fmac_f32 v91, v93, v102
    v_cvt_pk_bf16_f32 v106, v90, v91
    v_and_b32 v89, 0xffff0000, v11
    v_lshlrev_b32 v88, 16, v11
    v_sub_f32 v92, v88, v100
    v_cvt_pk_bf16_f32 v92, v92, v92
    v_lshlrev_b32 v92, 16, v92
    v_mul_f32 v90, v92, v102
    v_fma_f32 v93, -v90, v101, v92
    v_fmac_f32 v90, v93, v102
    v_sub_f32 v92, v89, v100
    v_cvt_pk_bf16_f32 v92, v92, v92
    v_lshlrev_b32 v92, 16, v92
    v_mul_f32 v91, v92, v102
    v_fma_f32 v93, -v91, v101, v92
    v_fmac_f32 v91, v93, v102
    v_cvt_pk_bf16_f32 v107, v90, v91
    v_and_b32 v89, 0xffff0000, v12
    v_lshlrev_b32 v88, 16, v12
    v_sub_f32 v92, v88, v100
    v_cvt_pk_bf16_f32 v92, v92, v92
    v_lshlrev_b32 v92, 16, v92
    v_mul_f32 v90, v92, v102
    v_fma_f32 v93, -v90, v101, v92
    v_fmac_f32 v90, v93, v102
    v_sub_f32 v92, v89, v100
    v_cvt_pk_bf16_f32 v92, v92, v92
    v_lshlrev_b32 v92, 16, v92
    v_mul_f32 v91, v92, v102
    v_fma_f32 v93, -v91, v101, v92
    v_fmac_f32 v91, v93, v102
    v_cvt_pk_bf16_f32 v108, v90, v91
    v_and_b32 v89, 0xffff0000, v13
    v_lshlrev_b32 v88, 16, v13
    v_sub_f32 v92, v88, v100
    v_cvt_pk_bf16_f32 v92, v92, v92
    v_lshlrev_b32 v92, 16, v92
    v_mul_f32 v90, v92, v102
    v_fma_f32 v93, -v90, v101, v92
    v_fmac_f32 v90, v93, v102
    v_sub_f32 v92, v89, v100
    v_cvt_pk_bf16_f32 v92, v92, v92
    v_lshlrev_b32 v92, 16, v92
    v_mul_f32 v91, v92, v102
    v_fma_f32 v93, -v91, v101, v92
    v_fmac_f32 v91, v93, v102
    v_cvt_pk_bf16_f32 v109, v90, v91
    v_and_b32 v89, 0xffff0000, v14
    v_lshlrev_b32 v88, 16, v14
    v_sub_f32 v92, v88, v100
    v_cvt_pk_bf16_f32 v92, v92, v92
    v_lshlrev_b32 v92, 16, v92
    v_mul_f32 v90, v92, v102
    v_fma_f32 v93, -v90, v101, v92
    v_fmac_f32 v90, v93, v102
    v_sub_f32 v92, v89, v100
    v_cvt_pk_bf16_f32 v92, v92, v92
    v_lshlrev_b32 v92, 16, v92
    v_mul_f32 v91, v92, v102
    v_fma_f32 v93, -v91, v101, v92
    v_fmac_f32 v91, v93, v102
    v_cvt_pk_bf16_f32 v110, v90, v91
    v_and_b32 v2, 1, v1
    v_lshlrev_b32 v2, 1, v2
    v_bfe_u32 v15, v1, 5, 1
    v_add_u32 v2, v2, v15
    v_lshlrev_b32 v2, 4, v2
    s_lshl_b32 s10, s66, 12
    s_add_u32 s10, s10, 4096
    s_lshl_b32 s11, s8, 7
    s_add_u32 s11, s11, s10
    v_mov_b32 v126, s64
    v_mov_b32 v127, s65
    ds_write_b64 v3, v[126:127] offset:1040
    s_mov_b32 s4, 3
    s_mov_b32 s5, 3
    s_waitcnt vmcnt(0)
    v_perm_b32 v120, v20, v16, s72
    v_perm_b32 v121, v20, v16, s73
    v_dot2_f32_bf16 v112, v120, v104, 0
    v_dot2_f32_bf16 v113, v121, v104, 0
    v_perm_b32 v120, v21, v17, s72
    v_perm_b32 v121, v21, v17, s73
    v_dot2_f32_bf16 v114, v120, v104, 0
    v_dot2_f32_bf16 v115, v121, v104, 0
    v_perm_b32 v120, v22, v18, s72
    v_perm_b32 v121, v22, v18, s73
    v_dot2_f32_bf16 v116, v120, v104, 0
    v_dot2_f32_bf16 v117, v121, v104, 0
    v_perm_b32 v120, v23, v19, s72
    v_perm_b32 v121, v23, v19, s73
    v_dot2_f32_bf16 v118, v120, v104, 0
    v_dot2_f32_bf16 v119, v121, v104, 0
    v_perm_b32 v120, v28, v24, s72
    v_perm_b32 v121, v28, v24, s73
    v_dot2_f32_bf16 v112, v120, v105, v112
    v_dot2_f32_bf16 v113, v121, v105, v113
    v_perm_b32 v120, v29, v25, s72
    v_perm_b32 v121, v29, v25, s73
    v_dot2_f32_bf16 v114, v120, v105, v114
    v_dot2_f32_bf16 v115, v121, v105, v115
    v_perm_b32 v120, v30, v26, s72
    v_perm_b32 v121, v30, v26, s73
    v_dot2_f32_bf16 v116, v120, v105, v116
    v_dot2_f32_bf16 v117, v121, v105, v117
    v_perm_b32 v120, v31, v27, s72
    v_perm_b32 v121, v31, v27, s73
    v_dot2_f32_bf16 v118, v120, v105, v118
    v_dot2_f32_bf16 v119, v121, v105, v119
    v_perm_b32 v120, v36, v32, s72
    v_perm_b32 v121, v36, v32, s73
    v_dot2_f32_bf16 v112, v120, v106, v112
    v_dot2_f32_bf16 v113, v121, v106, v113
    v_perm_b32 v120, v37, v33, s72
    v_perm_b32 v121, v37, v33, s73
    v_dot2_f32_bf16 v114, v120, v106, v114
    v_dot2_f32_bf16 v115, v121, v106, v115
    v_perm_b32 v120, v38, v34, s72
    v_perm_b32 v121, v38, v34, s73
    v_dot2_f32_bf16 v116, v120, v106, v116
    v_dot2_f32_bf16 v117, v121, v106, v117
    v_perm_b32 v120, v39, v35, s72
    v_perm_b32 v121, v39, v35, s73
    v_dot2_f32_bf16 v118, v120, v106, v118
    v_dot2_f32_bf16 v119, v121, v106, v119
    v_perm_b32 v120, v44, v40, s72
    v_perm_b32 v121, v44, v40, s73
    v_dot2_f32_bf16 v112, v120, v107, v112
    v_dot2_f32_bf16 v113, v121, v107, v113
    v_perm_b32 v120, v45, v41, s72
    v_perm_b32 v121, v45, v41, s73
    v_dot2_f32_bf16 v114, v120, v107, v114
    v_dot2_f32_bf16 v115, v121, v107, v115
    v_perm_b32 v120, v46, v42, s72
    v_perm_b32 v121, v46, v42, s73
    v_dot2_f32_bf16 v116, v120, v107, v116
    v_dot2_f32_bf16 v117, v121, v107, v117
    v_perm_b32 v120, v47, v43, s72
    v_perm_b32 v121, v47, v43, s73
    v_dot2_f32_bf16 v118, v120, v107, v118
    v_dot2_f32_bf16 v119, v121, v107, v119
    v_perm_b32 v120, v52, v48, s72
    v_perm_b32 v121, v52, v48, s73
    v_dot2_f32_bf16 v112, v120, v108, v112
    v_dot2_f32_bf16 v113, v121, v108, v113
    v_perm_b32 v120, v53, v49, s72
    v_perm_b32 v121, v53, v49, s73
    v_dot2_f32_bf16 v114, v120, v108, v114
    v_dot2_f32_bf16 v115, v121, v108, v115
    v_perm_b32 v120, v54, v50, s72
    v_perm_b32 v121, v54, v50, s73
    v_dot2_f32_bf16 v116, v120, v108, v116
    v_dot2_f32_bf16 v117, v121, v108, v117
    v_perm_b32 v120, v55, v51, s72
    v_perm_b32 v121, v55, v51, s73
    v_dot2_f32_bf16 v118, v120, v108, v118
    v_dot2_f32_bf16 v119, v121, v108, v119
    v_perm_b32 v120, v60, v56, s72
    v_perm_b32 v121, v60, v56, s73
    v_dot2_f32_bf16 v112, v120, v109, v112
    v_dot2_f32_bf16 v113, v121, v109, v113
    v_perm_b32 v120, v61, v57, s72
    v_perm_b32 v121, v61, v57, s73
    v_dot2_f32_bf16 v114, v120, v109, v114
    v_dot2_f32_bf16 v115, v121, v109, v115
    v_perm_b32 v120, v62, v58, s72
    v_perm_b32 v121, v62, v58, s73
    v_dot2_f32_bf16 v116, v120, v109, v116
    v_dot2_f32_bf16 v117, v121, v109, v117
    v_perm_b32 v120, v63, v59, s72
    v_perm_b32 v121, v63, v59, s73
    v_dot2_f32_bf16 v118, v120, v109, v118
    v_dot2_f32_bf16 v119, v121, v109, v119
    v_perm_b32 v120, v68, v64, s72
    v_perm_b32 v121, v68, v64, s73
    v_dot2_f32_bf16 v112, v120, v110, v112
    v_dot2_f32_bf16 v113, v121, v110, v113
    v_perm_b32 v120, v69, v65, s72
    v_perm_b32 v121, v69, v65, s73
    v_dot2_f32_bf16 v114, v120, v110, v114
    v_dot2_f32_bf16 v115, v121, v110, v115
    v_perm_b32 v120, v70, v66, s72
    v_perm_b32 v121, v70, v66, s73
    v_dot2_f32_bf16 v116, v120, v110, v116
    v_dot2_f32_bf16 v117, v121, v110, v117
    v_perm_b32 v120, v71, v67, s72
    v_perm_b32 v121, v71, v67, s73
    v_dot2_f32_bf16 v118, v120, v110, v118
    v_dot2_f32_bf16 v119, v121, v110, v119
    v_permlane32_swap_b32 v112, v116
    v_permlane32_swap_b32 v113, v117
    v_permlane32_swap_b32 v114, v118
    v_permlane32_swap_b32 v115, v119
    v_add_f32 v112, v112, v116
    v_add_f32 v113, v113, v117
    v_add_f32 v114, v114, v118
    v_add_f32 v115, v115, v119
    s_nop 0
    v_permlane16_swap_b32 v112, v114
    v_permlane16_swap_b32 v113, v115
    v_add_f32 v112, v112, v114
    v_add_f32 v113, v113, v115
    s_nop 0
    v_add_f32_dpp v112, v112, v112 row_ror:8 row_mask:0xf bank_mask:0xf
    v_add_f32_dpp v113, v113, v113 row_ror:8 row_mask:0xf bank_mask:0xf
    s_nop 0
    v_add_f32_dpp v112, v112, v112 row_ror:4 row_mask:0xf bank_mask:0xf
    v_add_f32_dpp v113, v113, v113 row_ror:4 row_mask:0xf bank_mask:0xf
    s_nop 0
    v_add_f32_dpp v112, v112, v112 row_ror:2 row_mask:0xf bank_mask:0xf
    v_add_f32_dpp v113, v113, v113 row_ror:2 row_mask:0xf bank_mask:0xf
    v_cvt_pk_bf16_f32 v124, v112, v113
    v_mov_b32 v125, v124
    s_nop 1
    v_permlane16_swap_b32 v124, v125
    s_mov_b64 exec, s[4:5]
    buffer_store_dwordx4 v[124:127], v2, s[60:63], s11 offen sc1
    s_mov_b64 exec, -1
    s_add_u32 s12, s10, 61440
    v_lshrrev_b32 v2, 2, v1
    v_lshlrev_b32 v2, 7, v2
    v_and_b32 v15, 3, v1
    v_lshl_add_u32 v2, v15, 4, v2
    v_lshlrev_b32 v15, 3, v1
    v_mov_b32 v4, 1
    buffer_load_dwordx4 v[80:83], v2, s[60:63], s10 offen sc1
    buffer_load_dwordx4 v[84:87], v2, s[60:63], s10 offen offset:2048 sc1
    s_sleep 12
    buffer_load_dwordx4 v[88:91], v2, s[60:63], s10 offen sc1
    buffer_load_dwordx4 v[92:95], v2, s[60:63], s10 offen offset:2048 sc1
    s_sleep 12
    buffer_load_dwordx4 v[96:99], v2, s[60:63], s10 offen sc1
    buffer_load_dwordx4 v[100:103], v2, s[60:63], s10 offen offset:2048 sc1
    s_sleep 12
    buffer_load_dwordx4 v[104:107], v2, s[60:63], s10 offen sc1
    buffer_load_dwordx4 v[108:111], v2, s[60:63], s10 offen offset:2048 sc1
    s_mov_b32 s88, 0
L_g1:
    s_nop 1
    s_waitcnt vmcnt(6)
    v_cmp_ne_u64 vcc, s[64:65], v[82:83]
    s_mov_b64 s[4:5], vcc
    v_cmp_ne_u64 vcc, s[64:65], v[86:87]
    s_or_b64 s[4:5], s[4:5], vcc
    s_cmp_eq_u64 s[4:5], 0
    s_cbranch_scc1 L_g1_ok0
    buffer_load_dwordx4 v[80:83], v2, s[60:63], s10 offen sc1
    buffer_load_dwordx4 v[84:87], v2, s[60:63], s10 offen offset:2048 sc1
    s_waitcnt vmcnt(6)
    v_cmp_ne_u64 vcc, s[64:65], v[90:91]
    s_mov_b64 s[4:5], vcc
    v_cmp_ne_u64 vcc, s[64:65], v[94:95]
    s_or_b64 s[4:5], s[4:5], vcc
    s_cmp_eq_u64 s[4:5], 0
    s_cbranch_scc1 L_g1_ok1
    buffer_load_dwordx4 v[88:91], v2, s[60:63], s10 offen sc1
    buffer_load_dwordx4 v[92:95], v2, s[60:63], s10 offen offset:2048 sc1
    s_waitcnt vmcnt(6)
    v_cmp_ne_u64 vcc, s[64:65], v[98:99]
    s_mov_b64 s[4:5], vcc
    v_cmp_ne_u64 vcc, s[64:65], v[102:103]
    s_or_b64 s[4:5], s[4:5], vcc
    s_cmp_eq_u64 s[4:5], 0
    s_cbranch_scc1 L_g1_ok2
    buffer_load_dwordx4 v[96:99], v2, s[60:63], s10 offen sc1
    buffer_load_dwordx4 v[100:103], v2, s[60:63], s10 offen offset:2048 sc1
    s_waitcnt vmcnt(6)
    v_cmp_ne_u64 vcc, s[64:65], v[106:107]
    s_mov_b64 s[4:5], vcc
    v_cmp_ne_u64 vcc, s[64:65], v[110:111]
    s_or_b64 s[4:5], s[4:5], vcc
    s_cmp_eq_u64 s[4:5], 0
    s_cbranch_scc1 L_g1_ok3
    buffer_load_dwordx4 v[104:107], v2, s[60:63], s10 offen sc1
    buffer_load_dwordx4 v[108:111], v2, s[60:63], s10 offen offset:2048 sc1
    s_add_u32 s88, s88, 1
    s_cmp_lt_u32 s88, 20000
    s_cbranch_scc1 L_g1
L_g1_ok0:
    s_nop 1
    ds_write_b64 v15, v[80:81] offset:0
    ds_write_b64 v15, v[84:85] offset:512
    s_branch L_g1_done
L_g1_ok1:
    s_nop 1
    ds_write_b64 v15, v[88:89] offset:0
    ds_write_b64 v15, v[92:93] offset:512
    s_branch L_g1_done
L_g1_ok2:
    s_nop 1
    ds_write_b64 v15, v[96:97] offset:0
    ds_write_b64 v15, v[100:101] offset:512
    s_branch L_g1_done
L_g1_ok3:
    s_nop 1
    ds_write_b64 v15, v[104:105] offset:0
    ds_write_b64 v15, v[108:109] offset:512
L_g1_done:
    s_nop 1
    s_waitcnt lgkmcnt(0)
    ds_write_b32 v3, v4 offset:1024
    s_mov_b32 s88, 0
L_cw0:
    ds_read_b32 v5, v3 offset:1028
    s_waitcnt lgkmcnt(0)
    v_readfirstlane_b32 s89, v5
    s_cmp_ge_u32 s89, 4
    s_cbranch_scc1 L_cw0_done
    s_add_u32 s88, s88, 1
    s_sleep 1
    s_cmp_lt_u32 s88, 800000
    s_cbranch_scc1 L_cw0
L_cw0_done:
    s_nop 1
    v_lshlrev_b32 v2, 4, v1
    s_mul_i32 s10, s77, 14336
    buffer_load_dwordx4 v[16:19], v2, s[52:55], s10 offen offset:0 nt
    buffer_load_dwordx4 v[20:23], v2, s[52:55], s10 offen offset:896 nt
    buffer_load_dwordx4 v[24:27], v2, s[52:55], s10 offen offset:1792 nt
    buffer_load_dwordx4 v[28:31], v2, s[52:55], s10 offen offset:2688 nt
    s_add_u32 s10, s10, 3584
    buffer_load_dwordx4 v[32:35], v2, s[52:55], s10 offen offset:0 nt
    buffer_load_dwordx4 v[36:39], v2, s[52:55], s10 offen offset:896 nt
    buffer_load_dwordx4 v[40:43], v2, s[52:55], s10 offen offset:1792 nt
    buffer_load_dwordx4 v[44:47], v2, s[52:55], s10 offen offset:2688 nt
    s_add_u32 s10, s10, 3584
    buffer_load_dwordx4 v[48:51], v2, s[52:55], s10 offen offset:0 nt
    buffer_load_dwordx4 v[52:55], v2, s[52:55], s10 offen offset:896 nt
    buffer_load_dwordx4 v[56:59], v2, s[52:55], s10 offen offset:1792 nt
    buffer_load_dwordx4 v[60:63], v2, s[52:55], s10 offen offset:2688 nt
    s_add_u32 s10, s10, 3584
    buffer_load_dwordx4 v[64:67], v2, s[52:55], s10 offen offset:0 nt
    buffer_load_dwordx4 v[68:71], v2, s[52:55], s10 offen offset:896 nt
    buffer_load_dwordx4 v[72:75], v2, s[52:55], s10 offen offset:1792 nt
    buffer_load_dwordx4 v[76:79], v2, s[52:55], s10 offen offset:2688 nt
    v_lshrrev_b32 v15, 3, v1
    v_lshlrev_b32 v15, 8, v15
    v_and_b32 v2, 7, v1
    v_lshl_add_u32 v2, v2, 4, v15
    s_lshl_b32 s10, s66, 18
    s_lshl_b32 s11, s67, 13
    s_add_u32 s10, s10, s11
    s_add_u32 s10, s10, 262144
    s_add_u32 s11, s10, 4096
    s_add_u32 s14, s10, 3932160
    s_add_u32 s15, s11, 3932160
    s_lshl_b32 s14, s66, 18
    s_and_b32 s15, s67, 16
    s_lshl_b32 s15, s15, 13
    s_add_u32 s14, s14, s15
    s_add_u32 s14, s14, 262144
    s_add_u32 s15, s14, 4096
    s_mul_i32 s12, s2, 3584
    s_add_u32 s12, s12, 2359296
    s_waitcnt vmcnt(0)
    v_perm_b32 v80, v20, v16, s72
    v_perm_b32 v20, v20, v16, s73
    v_mov_b32 v16, v80
    v_perm_b32 v80, v21, v17, s72
    v_perm_b32 v21, v21, v17, s73
    v_mov_b32 v17, v80
    v_perm_b32 v80, v22, v18, s72
    v_perm_b32 v22, v22, v18, s73
    v_mov_b32 v18, v80
    v_perm_b32 v80, v23, v19, s72
    v_perm_b32 v23, v23, v19, s73
    v_mov_b32 v19, v80
    v_perm_b32 v80, v28, v24, s72
    v_perm_b32 v28, v28, v24, s73
    v_mov_b32 v24, v80
    v_perm_b32 v80, v29, v25, s72
    v_perm_b32 v29, v29, v25, s73
    v_mov_b32 v25, v80
    v_perm_b32 v80, v30, v26, s72
    v_perm_b32 v30, v30, v26, s73
    v_mov_b32 v26, v80
    v_perm_b32 v80, v31, v27, s72
    v_perm_b32 v31, v31, v27, s73
    v_mov_b32 v27, v80
    v_perm_b32 v80, v36, v32, s72
    v_perm_b32 v36, v36, v32, s73
    v_mov_b32 v32, v80
    v_perm_b32 v80, v37, v33, s72
    v_perm_b32 v37, v37, v33, s73
    v_mov_b32 v33, v80
    v_perm_b32 v80, v38, v34, s72
    v_perm_b32 v38, v38, v34, s73
    v_mov_b32 v34, v80
    v_perm_b32 v80, v39, v35, s72
    v_perm_b32 v39, v39, v35, s73
    v_mov_b32 v35, v80
    v_perm_b32 v80, v44, v40, s72
    v_perm_b32 v44, v44, v40, s73
    v_mov_b32 v40, v80
    v_perm_b32 v80, v45, v41, s72
    v_perm_b32 v45, v45, v41, s73
    v_mov_b32 v41, v80
    v_perm_b32 v80, v46, v42, s72
    v_perm_b32 v46, v46, v42, s73
    v_mov_b32 v42, v80
    v_perm_b32 v80, v47, v43, s72
    v_perm_b32 v47, v47, v43, s73
    v_mov_b32 v43, v80
    v_perm_b32 v80, v52, v48, s72
    v_perm_b32 v52, v52, v48, s73
    v_mov_b32 v48, v80
    v_perm_b32 v80, v53, v49, s72
    v_perm_b32 v53, v53, v49, s73
    v_mov_b32 v49, v80
    v_perm_b32 v80, v54, v50, s72
    v_perm_b32 v54, v54, v50, s73
    v_mov_b32 v50, v80
    v_perm_b32 v80, v55, v51, s72
    v_perm_b32 v55, v55, v51, s73
    v_mov_b32 v51, v80
    v_perm_b32 v80, v60, v56, s72
    v_perm_b32 v60, v60, v56, s73
    v_mov_b32 v56, v80
    v_perm_b32 v80, v61, v57, s72
    v_perm_b32 v61, v61, v57, s73
    v_mov_b32 v57, v80
    v_perm_b32 v80, v62, v58, s72
    v_perm_b32 v62, v62, v58, s73
    v_mov_b32 v58, v80
    v_perm_b32 v80, v63, v59, s72
    v_perm_b32 v63, v63, v59, s73
    v_mov_b32 v59, v80
    v_perm_b32 v80, v68, v64, s72
    v_perm_b32 v68, v68, v64, s73
    v_mov_b32 v64, v80
    v_perm_b32 v80, v69, v65, s72
    v_perm_b32 v69, v69, v65, s73
    v_mov_b32 v65, v80
    v_perm_b32 v80, v70, v66, s72
    v_perm_b32 v70, v70, v66, s73
    v_mov_b32 v66, v80
    v_perm_b32 v80, v71, v67, s72
    v_perm_b32 v71, v71, v67, s73
    v_mov_b32 v67, v80
    v_perm_b32 v80, v76, v72, s72
    v_perm_b32 v76, v76, v72, s73
    v_mov_b32 v72, v80
    v_perm_b32 v80, v77, v73, s72
    v_perm_b32 v77, v77, v73, s73
    v_mov_b32 v73, v80
    v_perm_b32 v80, v78, v74, s72
    v_perm_b32 v78, v78, v74, s73
    v_mov_b32 v74, v80
    v_perm_b32 v80, v79, v75, s72
    v_perm_b32 v79, v79, v75, s73
    v_mov_b32 v75, v80
    s_mov_b32 s88, 0
L_cw:
    ds_read_b32 v4, v3 offset:1028
    s_waitcnt lgkmcnt(0)
    v_readfirstlane_b32 s89, v4
    s_cmp_ge_u32 s89, 9
    s_cbranch_scc1 L_cw_done
    s_add_u32 s88, s88, 1
    s_sleep 1
    s_cmp_lt_u32 s88, 800000
    s_cbranch_scc1 L_cw
L_cw_done:
    s_nop 1
    s_sleep 16
    buffer_load_dwordx4 v[80:83], v2, s[60:63], s10 offen offset:0 sc1
    buffer_load_dwordx4 v[84:87], v2, s[60:63], s10 offen offset:2048 sc1
    buffer_load_dwordx4 v[88:91], v2, s[60:63], s11 offen offset:0 sc1
    buffer_load_dwordx4 v[92:95], v2, s[60:63], s11 offen offset:2048 sc1
    buffer_load_dwordx4 v[96:99], v15, s[60:63], s14 offen offset:128 sc1
    buffer_load_dwordx4 v[100:103], v15, s[60:63], s14 offen offset:2176 sc1
    buffer_load_dwordx4 v[104:107], v15, s[60:63], s15 offen offset:128 sc1
    buffer_load_dwordx4 v[108:111], v15, s[60:63], s15 offen offset:2176 sc1
    s_sleep 8
    buffer_load_dwordx4 v[112:115], v2, s[60:63], s10 offen offset:0 sc1
    buffer_load_dwordx4 v[116:119], v2, s[60:63], s10 offen offset:2048 sc1
    buffer_load_dwordx4 v[120:123], v2, s[60:63], s11 offen offset:0 sc1
    buffer_load_dwordx4 v[124:127], v2, s[60:63], s11 offen offset:2048 sc1
    buffer_load_dwordx4 v[128:131], v15, s[60:63], s14 offen offset:128 sc1
    buffer_load_dwordx4 v[132:135], v15, s[60:63], s14 offen offset:2176 sc1
    buffer_load_dwordx4 v[136:139], v15, s[60:63], s15 offen offset:128 sc1
    buffer_load_dwordx4 v[140:143], v15, s[60:63], s15 offen offset:2176 sc1
    s_mov_b32 s88, 0
L_g2:
    s_nop 1
    s_waitcnt vmcnt(8)
    v_cmp_ne_u64 vcc, s[64:65], v[82:83]
    s_mov_b64 s[4:5], vcc
    v_cmp_ne_u64 vcc, s[64:65], v[86:87]
    s_or_b64 s[4:5], s[4:5], vcc
    v_cmp_ne_u64 vcc, s[64:65], v[90:91]
    s_or_b64 s[4:5], s[4:5], vcc
    v_cmp_ne_u64 vcc, s[64:65], v[94:95]
    s_or_b64 s[4:5], s[4:5], vcc
    v_cmp_ne_u64 vcc, s[64:65], v[98:99]
    s_or_b64 s[4:5], s[4:5], vcc
    v_cmp_ne_u64 vcc, s[64:65], v[102:103]
    s_or_b64 s[4:5], s[4:5], vcc
    v_cmp_ne_u64 vcc, s[64:65], v[106:107]
    s_or_b64 s[4:5], s[4:5], vcc
    v_cmp_ne_u64 vcc, s[64:65], v[110:111]
    s_or_b64 s[4:5], s[4:5], vcc
    s_cmp_eq_u64 s[4:5], 0
    s_cbranch_scc1 L_g2_ok0
    buffer_load_dwordx4 v[80:83], v2, s[60:63], s10 offen offset:0 sc1
    buffer_load_dwordx4 v[84:87], v2, s[60:63], s10 offen offset:2048 sc1
    buffer_load_dwordx4 v[88:91], v2, s[60:63], s11 offen offset:0 sc1
    buffer_load_dwordx4 v[92:95], v2, s[60:63], s11 offen offset:2048 sc1
    buffer_load_dwordx4 v[96:99], v15, s[60:63], s14 offen offset:128 sc1
    buffer_load_dwordx4 v[100:103], v15, s[60:63], s14 offen offset:2176 sc1
    buffer_load_dwordx4 v[104:107], v15, s[60:63], s15 offen offset:128 sc1
    buffer_load_dwordx4 v[108:111], v15, s[60:63], s15 offen offset:2176 sc1
    s_waitcnt vmcnt(8)
    v_cmp_ne_u64 vcc, s[64:65], v[114:115]
    s_mov_b64 s[4:5], vcc
    v_cmp_ne_u64 vcc, s[64:65], v[118:119]
    s_or_b64 s[4:5], s[4:5], vcc
    v_cmp_ne_u64 vcc, s[64:65], v[122:123]
    s_or_b64 s[4:5], s[4:5], vcc
    v_cmp_ne_u64 vcc, s[64:65], v[126:127]
    s_or_b64 s[4:5], s[4:5], vcc
    v_cmp_ne_u64 vcc, s[64:65], v[130:131]
    s_or_b64 s[4:5], s[4:5], vcc
    v_cmp_ne_u64 vcc, s[64:65], v[134:135]
    s_or_b64 s[4:5], s[4:5], vcc
    v_cmp_ne_u64 vcc, s[64:65], v[138:139]
    s_or_b64 s[4:5], s[4:5], vcc
    v_cmp_ne_u64 vcc, s[64:65], v[142:143]
    s_or_b64 s[4:5], s[4:5], vcc
    s_cmp_eq_u64 s[4:5], 0
    s_cbranch_scc1 L_g2_ok1
    buffer_load_dwordx4 v[112:115], v2, s[60:63], s10 offen offset:0 sc1
    buffer_load_dwordx4 v[116:119], v2, s[60:63], s10 offen offset:2048 sc1
    buffer_load_dwordx4 v[120:123], v2, s[60:63], s11 offen offset:0 sc1
    buffer_load_dwordx4 v[124:127], v2, s[60:63], s11 offen offset:2048 sc1
    buffer_load_dwordx4 v[128:131], v15, s[60:63], s14 offen offset:128 sc1
    buffer_load_dwordx4 v[132:135], v15, s[60:63], s14 offen offset:2176 sc1
    buffer_load_dwordx4 v[136:139], v15, s[60:63], s15 offen offset:128 sc1
    buffer_load_dwordx4 v[140:143], v15, s[60:63], s15 offen offset:2176 sc1
    s_add_u32 s88, s88, 1
    s_cmp_lt_u32 s88, 20000
    s_cbranch_scc1 L_g2
L_g2_ok0:
    s_nop 1
    v_mov_b32 v144, v80
    v_mov_b32 v145, v81
    v_mov_b32 v146, v84
    v_mov_b32 v147, v85
    v_mov_b32 v148, v88
    v_mov_b32 v149, v89
    v_mov_b32 v150, v92
    v_mov_b32 v151, v93
    v_mov_b32 v152, v96
    v_mov_b32 v153, v97
    v_mov_b32 v154, v100
    v_mov_b32 v155, v101
    v_mov_b32 v156, v104
    v_mov_b32 v157, v105
    v_mov_b32 v158, v108
    v_mov_b32 v159, v109
    s_branch L_g2_done
L_g2_ok1:
    s_nop 1
    v_mov_b32 v144, v112
    v_mov_b32 v145, v113
    v_mov_b32 v146, v116
    v_mov_b32 v147, v117
    v_mov_b32 v148, v120
    v_mov_b32 v149, v121
    v_mov_b32 v150, v124
    v_mov_b32 v151, v125
    v_mov_b32 v152, v128
    v_mov_b32 v153, v129
    v_mov_b32 v154, v132
    v_mov_b32 v155, v133
    v_mov_b32 v156, v136
    v_mov_b32 v157, v137
    v_mov_b32 v158, v140
    v_mov_b32 v159, v141
L_g2_done:
    s_nop 1
    v_max3_f32 v4, v152, v154, v156
    v_max_f32 v4, v4, v158
    s_nop 1
    v_max_f32_dpp v4, v4, v4 row_ror:1 row_mask:0xf bank_mask:0xf
    s_nop 1
    v_max_f32_dpp v4, v4, v4 row_ror:2 row_mask:0xf bank_mask:0xf
    s_nop 1
    v_max_f32_dpp v4, v4, v4 row_ror:4 row_mask:0xf bank_mask:0xf
    s_nop 1
    v_max_f32_dpp v4, v4, v4 row_ror:8 row_mask:0xf bank_mask:0xf
    v_mov_b32 v5, v4
    s_nop 1
    v_permlane16_swap_b32 v5, v4
    v_max_f32 v4, v4, v5
    v_mov_b32 v5, v4
    s_nop 1
    v_permlane32_swap_b32 v5, v4
    v_max_f32 v4, v4, v5
    v_sub_f32 v6, v152, v4
    v_sub_f32 v7, v154, v4
    v_sub_f32 v8, v156, v4
    v_sub_f32 v9, v158, v4
    v_mul_f32 v6, s76, v6
    v_mul_f32 v7, s76, v7
    v_mul_f32 v8, s76, v8
    v_mul_f32 v9, s76, v9
    v_exp_f32 v6, v6
    v_exp_f32 v7, v7
    v_exp_f32 v8, v8
    v_exp_f32 v9, v9
    v_mul_f32 v10, v6, v153
    v_mul_f32 v11, v6, v144
    v_mul_f32 v12, v6, v145
    v_fmac_f32 v10, v7, v155
    v_fmac_f32 v11, v7, v146
    v_fmac_f32 v12, v7, v147
    v_fmac_f32 v10, v8, v157
    v_fmac_f32 v11, v8, v148
    v_fmac_f32 v12, v8, v149
    v_fmac_f32 v10, v9, v159
    v_fmac_f32 v11, v9, v150
    v_fmac_f32 v12, v9, v151
    v_add_f32_dpp v10, v10, v10 row_ror:8 row_mask:0xf bank_mask:0xf
    v_add_f32_dpp v11, v11, v11 row_ror:8 row_mask:0xf bank_mask:0xf
    v_add_f32_dpp v12, v12, v12 row_ror:8 row_mask:0xf bank_mask:0xf
    v_mov_b32 v4, v10
    v_mov_b32 v5, v11
    v_mov_b32 v6, v12
    v_permlane16_swap_b32 v4, v10
    v_permlane16_swap_b32 v5, v11
    v_permlane16_swap_b32 v6, v12
    v_add_f32 v10, v10, v4
    v_add_f32 v11, v11, v5
    v_add_f32 v12, v12, v6
    v_mov_b32 v4, v10
    v_mov_b32 v5, v11
    v_mov_b32 v6, v12
    v_permlane32_swap_b32 v4, v10
    v_permlane32_swap_b32 v5, v11
    v_permlane32_swap_b32 v6, v12
    v_add_f32 v10, v10, v4
    v_add_f32 v11, v11, v5
    v_add_f32 v12, v12, v6
    v_rcp_f32 v13, v10
    s_nop 0
    v_mul_f32 v4, v11, v13
    v_fma_f32 v6, -v4, v10, v11
    v_fmac_f32 v4, v6, v13
    v_mul_f32 v5, v12, v13
    v_fma_f32 v6, -v5, v10, v12
    v_fmac_f32 v5, v6, v13
    v_cvt_pk_bf16_f32 v4, v4, v5
    s_nop 0
    v_readlane_b32 s80, v4, 0
    v_readlane_b32 s81, v4, 1
    v_readlane_b32 s82, v4, 2
    v_readlane_b32 s83, v4, 3
    v_readlane_b32 s84, v4, 4
    v_readlane_b32 s85, v4, 5
    v_readlane_b32 s86, v4, 6
    v_readlane_b32 s87, v4, 7
    v_mov_b32 v146, s64
    v_mov_b32 v147, s65
    v_mov_b32 v150, s64
    v_mov_b32 v151, s65
    v_mov_b32 v154, s64
    v_mov_b32 v155, s65
    v_mov_b32 v158, s64
    v_mov_b32 v159, s65
    v_dot2_f32_bf16 v144, v16, s80, 0
    v_dot2_f32_bf16 v145, v20, s80, 0
    v_dot2_f32_bf16 v148, v17, s80, 0
    v_dot2_f32_bf16 v149, v21, s80, 0
    v_dot2_f32_bf16 v152, v18, s80, 0
    v_dot2_f32_bf16 v153, v22, s80, 0
    v_dot2_f32_bf16 v156, v19, s80, 0
    v_dot2_f32_bf16 v157, v23, s80, 0
    v_dot2_f32_bf16 v144, v24, s81, v144
    v_dot2_f32_bf16 v145, v28, s81, v145
    v_dot2_f32_bf16 v148, v25, s81, v148
    v_dot2_f32_bf16 v149, v29, s81, v149
    v_dot2_f32_bf16 v152, v26, s81, v152
    v_dot2_f32_bf16 v153, v30, s81, v153
    v_dot2_f32_bf16 v156, v27, s81, v156
    v_dot2_f32_bf16 v157, v31, s81, v157
    v_dot2_f32_bf16 v144, v32, s82, v144
    v_dot2_f32_bf16 v145, v36, s82, v145
    v_dot2_f32_bf16 v148, v33, s82, v148
    v_dot2_f32_bf16 v149, v37, s82, v149
    v_dot2_f32_bf16 v152, v34, s82, v152
    v_dot2_f32_bf16 v153, v38, s82, v153
    v_dot2_f32_bf16 v156, v35, s82, v156
    v_dot2_f32_bf16 v157, v39, s82, v157
    v_dot2_f32_bf16 v144, v40, s83, v144
    v_dot2_f32_bf16 v145, v44, s83, v145
    v_dot2_f32_bf16 v148, v41, s83, v148
    v_dot2_f32_bf16 v149, v45, s83, v149
    v_dot2_f32_bf16 v152, v42, s83, v152
    v_dot2_f32_bf16 v153, v46, s83, v153
    v_dot2_f32_bf16 v156, v43, s83, v156
    v_dot2_f32_bf16 v157, v47, s83, v157
    v_dot2_f32_bf16 v144, v48, s84, v144
    v_dot2_f32_bf16 v145, v52, s84, v145
    v_dot2_f32_bf16 v148, v49, s84, v148
    v_dot2_f32_bf16 v149, v53, s84, v149
    v_dot2_f32_bf16 v152, v50, s84, v152
    v_dot2_f32_bf16 v153, v54, s84, v153
    v_dot2_f32_bf16 v156, v51, s84, v156
    v_dot2_f32_bf16 v157, v55, s84, v157
    v_dot2_f32_bf16 v144, v56, s85, v144
    v_dot2_f32_bf16 v145, v60, s85, v145
    v_dot2_f32_bf16 v148, v57, s85, v148
    v_dot2_f32_bf16 v149, v61, s85, v149
    v_dot2_f32_bf16 v152, v58, s85, v152
    v_dot2_f32_bf16 v153, v62, s85, v153
    v_dot2_f32_bf16 v156, v59, s85, v156
    v_dot2_f32_bf16 v157, v63, s85, v157
    v_dot2_f32_bf16 v144, v64, s86, v144
    v_dot2_f32_bf16 v145, v68, s86, v145
    v_dot2_f32_bf16 v148, v65, s86, v148
    v_dot2_f32_bf16 v149, v69, s86, v149
    v_dot2_f32_bf16 v152, v66, s86, v152
    v_dot2_f32_bf16 v153, v70, s86, v153
    v_dot2_f32_bf16 v156, v67, s86, v156
    v_dot2_f32_bf16 v157, v71, s86, v157
    v_dot2_f32_bf16 v144, v72, s87, v144
    v_dot2_f32_bf16 v145, v76, s87, v145
    v_dot2_f32_bf16 v148, v73, s87, v148
    v_dot2_f32_bf16 v149, v77, s87, v149
    v_dot2_f32_bf16 v152, v74, s87, v152
    v_dot2_f32_bf16 v153, v78, s87, v153
    v_dot2_f32_bf16 v156, v75, s87, v156
    v_dot2_f32_bf16 v157, v79, s87, v157
    v_lshlrev_b32 v2, 4, v1
    s_mov_b64 exec, s[74:75]
    buffer_store_dwordx4 v[144:147], v2, s[60:63], s12 offen offset:0 sc1
    buffer_store_dwordx4 v[148:151], v2, s[60:63], s12 offen offset:896 sc1
    buffer_store_dwordx4 v[152:155], v2, s[60:63], s12 offen offset:1792 sc1
    buffer_store_dwordx4 v[156:159], v2, s[60:63], s12 offen offset:2688 sc1
    s_mov_b64 exec, -1
    v_mov_b32 v4, 1
    ds_write_b32 v3, v4 offset:1032
    s_branch L_end
L_helper:
    s_nop 1
    s_cmp_ge_u32 s2, 112
    s_cbranch_scc1 L_end
    s_setprio 3
    s_mov_b32 s93, 3928064
    s_load_dword s68, s[40:41], s93
    s_and_b32 s8, s2, 15
    s_lshr_b32 s9, s2, 4
    s_mov_b32 s44, s16
    s_mov_b32 s45, s17
    s_mov_b32 s46, 896
    s_mov_b32 s47, 0x00020000
    s_mov_b32 s48, s28
    s_mov_b32 s49, s29
    s_mov_b32 s50, 1605632
    s_mov_b32 s51, 0x00020000
    s_mov_b32 s52, s32
    s_mov_b32 s53, s33
    s_mov_b32 s54, 1605632
    s_mov_b32 s55, 0x00020000
    s_mov_b32 s56, s30
    s_mov_b32 s57, s31
    s_mov_b32 s58, 3584
    s_mov_b32 s59, 0x00020000
    v_lshlrev_b32 v2, 4, v1
    buffer_load_dwordx4 v[4:7], v2, s[44:47], 0 offen
    v_lshrrev_b32 v15, 5, v1
    v_mul_u32_u24 v136, 28, v15
    s_mul_i32 s10, s8, 56
    buffer_load_dwordx4 v[8:11], v136, s[44:47], s10 offen
    buffer_load_dwordx3 v[12:14], v136, s[44:47], s10 offen offset:16
    v_and_b32 v136, 7, v1
    v_lshlrev_b32 v136, 2, v136
    s_lshl_b32 s10, s2, 5
    buffer_load_dword v163, v136, s[56:59], s10 offen
    v_mul_u32_u24 v15, 50176, v15
    v_and_b32 v136, 31, v1
    v_lshl_add_u32 v15, v136, 4, v15
    s_mul_i32 s10, s8, 100352
    s_lshl_b32 s11, s9, 9
    s_add_u32 s10, s10, s11
    s_barrier
    s_mov_b32 s13, s10
    buffer_load_dwordx4 v[16:19], v15, s[48:51], s13 offen nt
    s_add_u32 s13, s13, 3584
    buffer_load_dwordx4 v[20:23], v15, s[48:51], s13 offen nt
    s_add_u32 s13, s13, 3584
    buffer_load_dwordx4 v[24:27], v15, s[48:51], s13 offen nt
    s_add_u32 s13, s13, 3584
    buffer_load_dwordx4 v[28:31], v15, s[48:51], s13 offen nt
    s_add_u32 s13, s13, 3584
    buffer_load_dwordx4 v[32:35], v15, s[48:51], s13 offen nt
    s_add_u32 s13, s13, 3584
    buffer_load_dwordx4 v[36:39], v15, s[48:51], s13 offen nt
    s_add_u32 s13, s13, 3584
    buffer_load_dwordx4 v[40:43], v15, s[48:51], s13 offen nt
    s_add_u32 s13, s13, 3584
    buffer_load_dwordx4 v[44:47], v15, s[48:51], s13 offen nt
    s_add_u32 s13, s13, 3584
    buffer_load_dwordx4 v[48:51], v15, s[48:51], s13 offen nt
    s_add_u32 s13, s13, 3584
    buffer_load_dwordx4 v[52:55], v15, s[48:51], s13 offen nt
    s_add_u32 s13, s13, 3584
    buffer_load_dwordx4 v[56:59], v15, s[48:51], s13 offen nt
    s_add_u32 s13, s13, 3584
    buffer_load_dwordx4 v[60:63], v15, s[48:51], s13 offen nt
    s_add_u32 s13, s13, 3584
    buffer_load_dwordx4 v[64:67], v15, s[48:51], s13 offen nt
    s_add_u32 s13, s13, 3584
    buffer_load_dwordx4 v[68:71], v15, s[48:51], s13 offen nt
    s_waitcnt lgkmcnt(0)
    s_add_u32 s64, s68, 1
    s_mul_i32 s65, s64, 0x9E3779B1
    s_xor_b32 s65, s65, 0x85EBCA6B
    s_waitcnt vmcnt(15)
    v_and_b32 v137, 0xffff0000, v4
    v_lshlrev_b32 v136, 16, v4
    v_and_b32 v139, 0xffff0000, v5
    v_lshlrev_b32 v138, 16, v5
    v_and_b32 v141, 0xffff0000, v6
    v_lshlrev_b32 v140, 16, v6
    v_and_b32 v143, 0xffff0000, v7
    v_lshlrev_b32 v142, 16, v7
    v_add_f32 v144, v136, v137
    v_add_f32 v145, v138, v139
    v_add_f32 v146, v140, v141
    v_add_f32 v147, v142, v143
    v_add_f32 v144, v144, v145
    v_add_f32 v146, v146, v147
    v_add_f32 v144, v144, v146
    s_nop 1
    v_add_f32_dpp v144, v144, v144 row_ror:1 row_mask:0xf bank_mask:0xf
    s_nop 1
    v_add_f32_dpp v144, v144, v144 row_ror:2 row_mask:0xf bank_mask:0xf
    s_nop 1
    v_add_f32_dpp v144, v144, v144 row_ror:4 row_mask:0xf bank_mask:0xf
    s_nop 1
    v_add_f32_dpp v144, v144, v144 row_ror:8 row_mask:0xf bank_mask:0xf
    v_mov_b32 v145, v144
    s_nop 1
    v_permlane16_swap_b32 v145, v144
    v_add_f32 v144, v144, v145
    v_mov_b32 v145, v144
    s_nop 1
    v_permlane32_swap_b32 v145, v144
    v_add_f32 v144, v144, v145
    v_mul_f32 v144, 0x3b124925, v144
    v_mov_b32 v145, 0
    v_sub_f32 v146, v136, v144
    v_fmac_f32 v145, v146, v146
    v_sub_f32 v146, v137, v144
    v_fmac_f32 v145, v146, v146
    v_sub_f32 v146, v138, v144
    v_fmac_f32 v145, v146, v146
    v_sub_f32 v146, v139, v144
    v_fmac_f32 v145, v146, v146
    v_sub_f32 v146, v140, v144
    v_fmac_f32 v145, v146, v146
    v_sub_f32 v146, v141, v144
    v_fmac_f32 v145, v146, v146
    v_sub_f32 v146, v142, v144
    v_fmac_f32 v145, v146, v146
    v_sub_f32 v146, v143, v144
    v_fmac_f32 v145, v146, v146
    v_cndmask_b32 v145, 0, v145, s[74:75]
    s_nop 1
    v_add_f32_dpp v145, v145, v145 row_ror:1 row_mask:0xf bank_mask:0xf
    s_nop 1
    v_add_f32_dpp v145, v145, v145 row_ror:2 row_mask:0xf bank_mask:0xf
    s_nop 1
    v_add_f32_dpp v145, v145, v145 row_ror:4 row_mask:0xf bank_mask:0xf
    s_nop 1
    v_add_f32_dpp v145, v145, v145 row_ror:8 row_mask:0xf bank_mask:0xf
    v_mov_b32 v146, v145
    s_nop 1
    v_permlane16_swap_b32 v146, v145
    v_add_f32 v145, v145, v146
    v_mov_b32 v146, v145
    s_nop 1
    v_permlane32_swap_b32 v146, v145
    v_add_f32 v145, v145, v146
    v_mul_f32 v145, 0x3b124925, v145
    v_cvt_pk_bf16_f32 v152, v144, v144
    v_lshlrev_b32 v152, 16, v152
    v_cvt_pk_bf16_f32 v145, v145, v145
    v_lshlrev_b32 v145, 16, v145
    v_add_f32 v145, 0x3727c5ac, v145
    v_cvt_pk_bf16_f32 v145, v145, v145
    v_lshlrev_b32 v145, 16, v145
    v_sqrt_f32 v145, v145
    s_nop 0
    v_cvt_pk_bf16_f32 v153, v145, v145
    v_lshlrev_b32 v153, 16, v153
    v_rcp_f32 v154, v153
    v_sub_f32 v144, v136, v152
    v_cvt_pk_bf16_f32 v144, v144, v144
    v_lshlrev_b32 v144, 16, v144
    v_mul_f32 v148, v144, v154
    v_fma_f32 v145, -v148, v153, v144
    v_fmac_f32 v148, v145, v154
    v_cvt_pk_bf16_f32 v148, v148, v148
    v_lshlrev_b32 v148, 16, v148
    v_cndmask_b32 v136, 0, v148, s[74:75]
    v_sub_f32 v144, v137, v152
    v_cvt_pk_bf16_f32 v144, v144, v144
    v_lshlrev_b32 v144, 16, v144
    v_mul_f32 v148, v144, v154
    v_fma_f32 v145, -v148, v153, v144
    v_fmac_f32 v148, v145, v154
    v_cvt_pk_bf16_f32 v148, v148, v148
    v_lshlrev_b32 v148, 16, v148
    v_cndmask_b32 v137, 0, v148, s[74:75]
    v_sub_f32 v144, v138, v152
    v_cvt_pk_bf16_f32 v144, v144, v144
    v_lshlrev_b32 v144, 16, v144
    v_mul_f32 v148, v144, v154
    v_fma_f32 v145, -v148, v153, v144
    v_fmac_f32 v148, v145, v154
    v_cvt_pk_bf16_f32 v148, v148, v148
    v_lshlrev_b32 v148, 16, v148
    v_cndmask_b32 v138, 0, v148, s[74:75]
    v_sub_f32 v144, v139, v152
    v_cvt_pk_bf16_f32 v144, v144, v144
    v_lshlrev_b32 v144, 16, v144
    v_mul_f32 v148, v144, v154
    v_fma_f32 v145, -v148, v153, v144
    v_fmac_f32 v148, v145, v154
    v_cvt_pk_bf16_f32 v148, v148, v148
    v_lshlrev_b32 v148, 16, v148
    v_cndmask_b32 v139, 0, v148, s[74:75]
    v_sub_f32 v144, v140, v152
    v_cvt_pk_bf16_f32 v144, v144, v144
    v_lshlrev_b32 v144, 16, v144
    v_mul_f32 v148, v144, v154
    v_fma_f32 v145, -v148, v153, v144
    v_fmac_f32 v148, v145, v154
    v_cvt_pk_bf16_f32 v148, v148, v148
    v_lshlrev_b32 v148, 16, v148
    v_cndmask_b32 v140, 0, v148, s[74:75]
    v_sub_f32 v144, v141, v152
    v_cvt_pk_bf16_f32 v144, v144, v144
    v_lshlrev_b32 v144, 16, v144
    v_mul_f32 v148, v144, v154
    v_fma_f32 v145, -v148, v153, v144
    v_fmac_f32 v148, v145, v154
    v_cvt_pk_bf16_f32 v148, v148, v148
    v_lshlrev_b32 v148, 16, v148
    v_cndmask_b32 v141, 0, v148, s[74:75]
    v_sub_f32 v144, v142, v152
    v_cvt_pk_bf16_f32 v144, v144, v144
    v_lshlrev_b32 v144, 16, v144
    v_mul_f32 v148, v144, v154
    v_fma_f32 v145, -v148, v153, v144
    v_fmac_f32 v148, v145, v154
    v_cvt_pk_bf16_f32 v148, v148, v148
    v_lshlrev_b32 v148, 16, v148
    v_cndmask_b32 v142, 0, v148, s[74:75]
    v_sub_f32 v144, v143, v152
    v_cvt_pk_bf16_f32 v144, v144, v144
    v_lshlrev_b32 v144, 16, v144
    v_mul_f32 v148, v144, v154
    v_fma_f32 v145, -v148, v153, v144
    v_fmac_f32 v148, v145, v154
    v_cvt_pk_bf16_f32 v148, v148, v148
    v_lshlrev_b32 v148, 16, v148
    v_cndmask_b32 v143, 0, v148, s[74:75]
    v_and_b32 v149, 0xffff0000, v8
    v_lshlrev_b32 v148, 16, v8
    v_sub_f32 v144, v148, v152
    v_cvt_pk_bf16_f32 v144, v144, v144
    v_lshlrev_b32 v144, 16, v144
    v_mul_f32 v150, v144, v154
    v_fma_f32 v145, -v150, v153, v144
    v_fmac_f32 v150, v145, v154
    v_sub_f32 v144, v149, v152
    v_cvt_pk_bf16_f32 v144, v144, v144
    v_lshlrev_b32 v144, 16, v144
    v_mul_f32 v151, v144, v154
    v_fma_f32 v145, -v151, v153, v144
    v_fmac_f32 v151, v145, v154
    v_cvt_pk_bf16_f32 v8, v150, v151
    v_and_b32 v149, 0xffff0000, v9
    v_lshlrev_b32 v148, 16, v9
    v_sub_f32 v144, v148, v152
    v_cvt_pk_bf16_f32 v144, v144, v144
    v_lshlrev_b32 v144, 16, v144
    v_mul_f32 v150, v144, v154
    v_fma_f32 v145, -v150, v153, v144
    v_fmac_f32 v150, v145, v154
    v_sub_f32 v144, v149, v152
    v_cvt_pk_bf16_f32 v144, v144, v144
    v_lshlrev_b32 v144, 16, v144
    v_mul_f32 v151, v144, v154
    v_fma_f32 v145, -v151, v153, v144
    v_fmac_f32 v151, v145, v154
    v_cvt_pk_bf16_f32 v9, v150, v151
    v_and_b32 v149, 0xffff0000, v10
    v_lshlrev_b32 v148, 16, v10
    v_sub_f32 v144, v148, v152
    v_cvt_pk_bf16_f32 v144, v144, v144
    v_lshlrev_b32 v144, 16, v144
    v_mul_f32 v150, v144, v154
    v_fma_f32 v145, -v150, v153, v144
    v_fmac_f32 v150, v145, v154
    v_sub_f32 v144, v149, v152
    v_cvt_pk_bf16_f32 v144, v144, v144
    v_lshlrev_b32 v144, 16, v144
    v_mul_f32 v151, v144, v154
    v_fma_f32 v145, -v151, v153, v144
    v_fmac_f32 v151, v145, v154
    v_cvt_pk_bf16_f32 v10, v150, v151
    v_and_b32 v149, 0xffff0000, v11
    v_lshlrev_b32 v148, 16, v11
    v_sub_f32 v144, v148, v152
    v_cvt_pk_bf16_f32 v144, v144, v144
    v_lshlrev_b32 v144, 16, v144
    v_mul_f32 v150, v144, v154
    v_fma_f32 v145, -v150, v153, v144
    v_fmac_f32 v150, v145, v154
    v_sub_f32 v144, v149, v152
    v_cvt_pk_bf16_f32 v144, v144, v144
    v_lshlrev_b32 v144, 16, v144
    v_mul_f32 v151, v144, v154
    v_fma_f32 v145, -v151, v153, v144
    v_fmac_f32 v151, v145, v154
    v_cvt_pk_bf16_f32 v11, v150, v151
    v_and_b32 v149, 0xffff0000, v12
    v_lshlrev_b32 v148, 16, v12
    v_sub_f32 v144, v148, v152
    v_cvt_pk_bf16_f32 v144, v144, v144
    v_lshlrev_b32 v144, 16, v144
    v_mul_f32 v150, v144, v154
    v_fma_f32 v145, -v150, v153, v144
    v_fmac_f32 v150, v145, v154
    v_sub_f32 v144, v149, v152
    v_cvt_pk_bf16_f32 v144, v144, v144
    v_lshlrev_b32 v144, 16, v144
    v_mul_f32 v151, v144, v154
    v_fma_f32 v145, -v151, v153, v144
    v_fmac_f32 v151, v145, v154
    v_cvt_pk_bf16_f32 v12, v150, v151
    v_and_b32 v149, 0xffff0000, v13
    v_lshlrev_b32 v148, 16, v13
    v_sub_f32 v144, v148, v152
    v_cvt_pk_bf16_f32 v144, v144, v144
    v_lshlrev_b32 v144, 16, v144
    v_mul_f32 v150, v144, v154
    v_fma_f32 v145, -v150, v153, v144
    v_fmac_f32 v150, v145, v154
    v_sub_f32 v144, v149, v152
    v_cvt_pk_bf16_f32 v144, v144, v144
    v_lshlrev_b32 v144, 16, v144
    v_mul_f32 v151, v144, v154
    v_fma_f32 v145, -v151, v153, v144
    v_fmac_f32 v151, v145, v154
    v_cvt_pk_bf16_f32 v13, v150, v151
    v_and_b32 v149, 0xffff0000, v14
    v_lshlrev_b32 v148, 16, v14
    v_sub_f32 v144, v148, v152
    v_cvt_pk_bf16_f32 v144, v144, v144
    v_lshlrev_b32 v144, 16, v144
    v_mul_f32 v150, v144, v154
    v_fma_f32 v145, -v150, v153, v144
    v_fmac_f32 v150, v145, v154
    v_sub_f32 v144, v149, v152
    v_cvt_pk_bf16_f32 v144, v144, v144
    v_lshlrev_b32 v144, 16, v144
    v_mul_f32 v151, v144, v154
    v_fma_f32 v145, -v151, v153, v144
    v_fmac_f32 v151, v145, v154
    v_cvt_pk_bf16_f32 v14, v150, v151
    v_add_f32 v144, v136, v137
    v_add_f32 v145, v138, v139
    v_add_f32 v146, v140, v141
    v_add_f32 v147, v142, v143
    v_add_f32 v144, v144, v145
    v_add_f32 v146, v146, v147
    v_add_f32 v144, v144, v146
    s_nop 1
    v_add_f32_dpp v144, v144, v144 row_ror:1 row_mask:0xf bank_mask:0xf
    s_nop 1
    v_add_f32_dpp v144, v144, v144 row_ror:2 row_mask:0xf bank_mask:0xf
    s_nop 1
    v_add_f32_dpp v144, v144, v144 row_ror:4 row_mask:0xf bank_mask:0xf
    s_nop 1
    v_add_f32_dpp v144, v144, v144 row_ror:8 row_mask:0xf bank_mask:0xf
    v_mov_b32 v145, v144
    s_nop 1
    v_permlane16_swap_b32 v145, v144
    v_add_f32 v144, v144, v145
    v_mov_b32 v145, v144
    s_nop 1
    v_permlane32_swap_b32 v145, v144
    v_add_f32 v144, v144, v145
    v_mul_f32 v144, 0x3b124925, v144
    v_mov_b32 v145, 0
    v_sub_f32 v146, v136, v144
    v_fmac_f32 v145, v146, v146
    v_sub_f32 v146, v137, v144
    v_fmac_f32 v145, v146, v146
    v_sub_f32 v146, v138, v144
    v_fmac_f32 v145, v146, v146
    v_sub_f32 v146, v139, v144
    v_fmac_f32 v145, v146, v146
    v_sub_f32 v146, v140, v144
    v_fmac_f32 v145, v146, v146
    v_sub_f32 v146, v141, v144
    v_fmac_f32 v145, v146, v146
    v_sub_f32 v146, v142, v144
    v_fmac_f32 v145, v146, v146
    v_sub_f32 v146, v143, v144
    v_fmac_f32 v145, v146, v146
    v_cndmask_b32 v145, 0, v145, s[74:75]
    s_nop 1
    v_add_f32_dpp v145, v145, v145 row_ror:1 row_mask:0xf bank_mask:0xf
    s_nop 1
    v_add_f32_dpp v145, v145, v145 row_ror:2 row_mask:0xf bank_mask:0xf
    s_nop 1
    v_add_f32_dpp v145, v145, v145 row_ror:4 row_mask:0xf bank_mask:0xf
    s_nop 1
    v_add_f32_dpp v145, v145, v145 row_ror:8 row_mask:0xf bank_mask:0xf
    v_mov_b32 v146, v145
    s_nop 1
    v_permlane16_swap_b32 v146, v145
    v_add_f32 v145, v145, v146
    v_mov_b32 v146, v145
    s_nop 1
    v_permlane32_swap_b32 v146, v145
    v_add_f32 v145, v145, v146
    v_mul_f32 v145, 0x3b124925, v145
    v_cvt_pk_bf16_f32 v152, v144, v144
    v_lshlrev_b32 v152, 16, v152
    v_cvt_pk_bf16_f32 v145, v145, v145
    v_lshlrev_b32 v145, 16, v145
    v_add_f32 v145, 0x3727c5ac, v145
    v_cvt_pk_bf16_f32 v145, v145, v145
    v_lshlrev_b32 v145, 16, v145
    v_sqrt_f32 v145, v145
    s_nop 0
    v_cvt_pk_bf16_f32 v153, v145, v145
    v_lshlrev_b32 v153, 16, v153
    v_rcp_f32 v154, v153
    v_and_b32 v149, 0xffff0000, v8
    v_lshlrev_b32 v148, 16, v8
    v_sub_f32 v144, v148, v152
    v_cvt_pk_bf16_f32 v144, v144, v144
    v_lshlrev_b32 v144, 16, v144
    v_mul_f32 v150, v144, v154
    v_fma_f32 v145, -v150, v153, v144
    v_fmac_f32 v150, v145, v154
    v_sub_f32 v144, v149, v152
    v_cvt_pk_bf16_f32 v144, v144, v144
    v_lshlrev_b32 v144, 16, v144
    v_mul_f32 v151, v144, v154
    v_fma_f32 v145, -v151, v153, v144
    v_fmac_f32 v151, v145, v154
    v_cvt_pk_bf16_f32 v156, v150, v151
    v_and_b32 v149, 0xffff0000, v9
    v_lshlrev_b32 v148, 16, v9
    v_sub_f32 v144, v148, v152
    v_cvt_pk_bf16_f32 v144, v144, v144
    v_lshlrev_b32 v144, 16, v144
    v_mul_f32 v150, v144, v154
    v_fma_f32 v145, -v150, v153, v144
    v_fmac_f32 v150, v145, v154
    v_sub_f32 v144, v149, v152
    v_cvt_pk_bf16_f32 v144, v144, v144
    v_lshlrev_b32 v144, 16, v144
    v_mul_f32 v151, v144, v154
    v_fma_f32 v145, -v151, v153, v144
    v_fmac_f32 v151, v145, v154
    v_cvt_pk_bf16_f32 v157, v150, v151
    v_and_b32 v149, 0xffff0000, v10
    v_lshlrev_b32 v148, 16, v10
    v_sub_f32 v144, v148, v152
    v_cvt_pk_bf16_f32 v144, v144, v144
    v_lshlrev_b32 v144, 16, v144
    v_mul_f32 v150, v144, v154
    v_fma_f32 v145, -v150, v153, v144
    v_fmac_f32 v150, v145, v154
    v_sub_f32 v144, v149, v152
    v_cvt_pk_bf16_f32 v144, v144, v144
    v_lshlrev_b32 v144, 16, v144
    v_mul_f32 v151, v144, v154
    v_fma_f32 v145, -v151, v153, v144
    v_fmac_f32 v151, v145, v154
    v_cvt_pk_bf16_f32 v158, v150, v151
    v_and_b32 v149, 0xffff0000, v11
    v_lshlrev_b32 v148, 16, v11
    v_sub_f32 v144, v148, v152
    v_cvt_pk_bf16_f32 v144, v144, v144
    v_lshlrev_b32 v144, 16, v144
    v_mul_f32 v150, v144, v154
    v_fma_f32 v145, -v150, v153, v144
    v_fmac_f32 v150, v145, v154
    v_sub_f32 v144, v149, v152
    v_cvt_pk_bf16_f32 v144, v144, v144
    v_lshlrev_b32 v144, 16, v144
    v_mul_f32 v151, v144, v154
    v_fma_f32 v145, -v151, v153, v144
    v_fmac_f32 v151, v145, v154
    v_cvt_pk_bf16_f32 v159, v150, v151
    v_and_b32 v149, 0xffff0000, v12
    v_lshlrev_b32 v148, 16, v12
    v_sub_f32 v144, v148, v152
    v_cvt_pk_bf16_f32 v144, v144, v144
    v_lshlrev_b32 v144, 16, v144
    v_mul_f32 v150, v144, v154
    v_fma_f32 v145, -v150, v153, v144
    v_fmac_f32 v150, v145, v154
    v_sub_f32 v144, v149, v152
    v_cvt_pk_bf16_f32 v144, v144, v144
    v_lshlrev_b32 v144, 16, v144
    v_mul_f32 v151, v144, v154
    v_fma_f32 v145, -v151, v153, v144
    v_fmac_f32 v151, v145, v154
    v_cvt_pk_bf16_f32 v160, v150, v151
    v_and_b32 v149, 0xffff0000, v13
    v_lshlrev_b32 v148, 16, v13
    v_sub_f32 v144, v148, v152
    v_cvt_pk_bf16_f32 v144, v144, v144
    v_lshlrev_b32 v144, 16, v144
    v_mul_f32 v150, v144, v154
    v_fma_f32 v145, -v150, v153, v144
    v_fmac_f32 v150, v145, v154
    v_sub_f32 v144, v149, v152
    v_cvt_pk_bf16_f32 v144, v144, v144
    v_lshlrev_b32 v144, 16, v144
    v_mul_f32 v151, v144, v154
    v_fma_f32 v145, -v151, v153, v144
    v_fmac_f32 v151, v145, v154
    v_cvt_pk_bf16_f32 v161, v150, v151
    v_and_b32 v149, 0xffff0000, v14
    v_lshlrev_b32 v148, 16, v14
    v_sub_f32 v144, v148, v152
    v_cvt_pk_bf16_f32 v144, v144, v144
    v_lshlrev_b32 v144, 16, v144
    v_mul_f32 v150, v144, v154
    v_fma_f32 v145, -v150, v153, v144
    v_fmac_f32 v150, v145, v154
    v_sub_f32 v144, v149, v152
    v_cvt_pk_bf16_f32 v144, v144, v144
    v_lshlrev_b32 v144, 16, v144
    v_mul_f32 v151, v144, v154
    v_fma_f32 v145, -v151, v153, v144
    v_fmac_f32 v151, v145, v154
    v_cvt_pk_bf16_f32 v162, v150, v151
    v_bfe_u32 v4, v1, 1, 4
    v_lshlrev_b32 v4, 11, v4
    v_and_b32 v5, 1, v1
    v_lshl_add_u32 v4, v5, 6, v4
    v_lshrrev_b32 v5, 5, v1
    v_lshl_add_u32 v4, v5, 5, v4
    s_lshl_b32 s10, s9, 15
    s_lshl_b32 s11, s8, 7
    s_add_u32 s10, s10, s11
    s_add_u32 s10, s10, 3686400
    v_mov_b32 v10, s64
    v_mov_b32 v11, s65
    v_mov_b32 v14, s64
    v_mov_b32 v15, s65
    s_waitcnt vmcnt(0)
    v_perm_b32 v144, v20, v16, s72
    v_perm_b32 v145, v20, v16, s73
    v_dot2_f32_bf16 v136, v144, v156, 0
    v_dot2_f32_bf16 v137, v145, v156, 0
    v_perm_b32 v144, v21, v17, s72
    v_perm_b32 v145, v21, v17, s73
    v_dot2_f32_bf16 v138, v144, v156, 0
    v_dot2_f32_bf16 v139, v145, v156, 0
    v_perm_b32 v144, v22, v18, s72
    v_perm_b32 v145, v22, v18, s73
    v_dot2_f32_bf16 v140, v144, v156, 0
    v_dot2_f32_bf16 v141, v145, v156, 0
    v_perm_b32 v144, v23, v19, s72
    v_perm_b32 v145, v23, v19, s73
    v_dot2_f32_bf16 v142, v144, v156, 0
    v_dot2_f32_bf16 v143, v145, v156, 0
    v_perm_b32 v144, v28, v24, s72
    v_perm_b32 v145, v28, v24, s73
    v_dot2_f32_bf16 v136, v144, v157, v136
    v_dot2_f32_bf16 v137, v145, v157, v137
    v_perm_b32 v144, v29, v25, s72
    v_perm_b32 v145, v29, v25, s73
    v_dot2_f32_bf16 v138, v144, v157, v138
    v_dot2_f32_bf16 v139, v145, v157, v139
    v_perm_b32 v144, v30, v26, s72
    v_perm_b32 v145, v30, v26, s73
    v_dot2_f32_bf16 v140, v144, v157, v140
    v_dot2_f32_bf16 v141, v145, v157, v141
    v_perm_b32 v144, v31, v27, s72
    v_perm_b32 v145, v31, v27, s73
    v_dot2_f32_bf16 v142, v144, v157, v142
    v_dot2_f32_bf16 v143, v145, v157, v143
    v_perm_b32 v144, v36, v32, s72
    v_perm_b32 v145, v36, v32, s73
    v_dot2_f32_bf16 v136, v144, v158, v136
    v_dot2_f32_bf16 v137, v145, v158, v137
    v_perm_b32 v144, v37, v33, s72
    v_perm_b32 v145, v37, v33, s73
    v_dot2_f32_bf16 v138, v144, v158, v138
    v_dot2_f32_bf16 v139, v145, v158, v139
    v_perm_b32 v144, v38, v34, s72
    v_perm_b32 v145, v38, v34, s73
    v_dot2_f32_bf16 v140, v144, v158, v140
    v_dot2_f32_bf16 v141, v145, v158, v141
    v_perm_b32 v144, v39, v35, s72
    v_perm_b32 v145, v39, v35, s73
    v_dot2_f32_bf16 v142, v144, v158, v142
    v_dot2_f32_bf16 v143, v145, v158, v143
    v_perm_b32 v144, v44, v40, s72
    v_perm_b32 v145, v44, v40, s73
    v_dot2_f32_bf16 v136, v144, v159, v136
    v_dot2_f32_bf16 v137, v145, v159, v137
    v_perm_b32 v144, v45, v41, s72
    v_perm_b32 v145, v45, v41, s73
    v_dot2_f32_bf16 v138, v144, v159, v138
    v_dot2_f32_bf16 v139, v145, v159, v139
    v_perm_b32 v144, v46, v42, s72
    v_perm_b32 v145, v46, v42, s73
    v_dot2_f32_bf16 v140, v144, v159, v140
    v_dot2_f32_bf16 v141, v145, v159, v141
    v_perm_b32 v144, v47, v43, s72
    v_perm_b32 v145, v47, v43, s73
    v_dot2_f32_bf16 v142, v144, v159, v142
    v_dot2_f32_bf16 v143, v145, v159, v143
    v_perm_b32 v144, v52, v48, s72
    v_perm_b32 v145, v52, v48, s73
    v_dot2_f32_bf16 v136, v144, v160, v136
    v_dot2_f32_bf16 v137, v145, v160, v137
    v_perm_b32 v144, v53, v49, s72
    v_perm_b32 v145, v53, v49, s73
    v_dot2_f32_bf16 v138, v144, v160, v138
    v_dot2_f32_bf16 v139, v145, v160, v139
    v_perm_b32 v144, v54, v50, s72
    v_perm_b32 v145, v54, v50, s73
    v_dot2_f32_bf16 v140, v144, v160, v140
    v_dot2_f32_bf16 v141, v145, v160, v141
    v_perm_b32 v144, v55, v51, s72
    v_perm_b32 v145, v55, v51, s73
    v_dot2_f32_bf16 v142, v144, v160, v142
    v_dot2_f32_bf16 v143, v145, v160, v143
    v_perm_b32 v144, v60, v56, s72
    v_perm_b32 v145, v60, v56, s73
    v_dot2_f32_bf16 v136, v144, v161, v136
    v_dot2_f32_bf16 v137, v145, v161, v137
    v_perm_b32 v144, v61, v57, s72
    v_perm_b32 v145, v61, v57, s73
    v_dot2_f32_bf16 v138, v144, v161, v138
    v_dot2_f32_bf16 v139, v145, v161, v139
    v_perm_b32 v144, v62, v58, s72
    v_perm_b32 v145, v62, v58, s73
    v_dot2_f32_bf16 v140, v144, v161, v140
    v_dot2_f32_bf16 v141, v145, v161, v141
    v_perm_b32 v144, v63, v59, s72
    v_perm_b32 v145, v63, v59, s73
    v_dot2_f32_bf16 v142, v144, v161, v142
    v_dot2_f32_bf16 v143, v145, v161, v143
    v_perm_b32 v144, v68, v64, s72
    v_perm_b32 v145, v68, v64, s73
    v_dot2_f32_bf16 v136, v144, v162, v136
    v_dot2_f32_bf16 v137, v145, v162, v137
    v_perm_b32 v144, v69, v65, s72
    v_perm_b32 v145, v69, v65, s73
    v_dot2_f32_bf16 v138, v144, v162, v138
    v_dot2_f32_bf16 v139, v145, v162, v139
    v_perm_b32 v144, v70, v66, s72
    v_perm_b32 v145, v70, v66, s73
    v_dot2_f32_bf16 v140, v144, v162, v140
    v_dot2_f32_bf16 v141, v145, v162, v141
    v_perm_b32 v144, v71, v67, s72
    v_perm_b32 v145, v71, v67, s73
    v_dot2_f32_bf16 v142, v144, v162, v142
    v_dot2_f32_bf16 v143, v145, v162, v143
    v_permlane32_swap_b32 v136, v140
    v_permlane32_swap_b32 v137, v141
    v_permlane32_swap_b32 v138, v142
    v_permlane32_swap_b32 v139, v143
    v_add_f32 v8, v136, v140
    v_add_f32 v9, v137, v141
    v_add_f32 v12, v138, v142
    v_add_f32 v13, v139, v143
    buffer_store_dwordx4 v[8:11], v4, s[60:63], s10 offen sc1
    buffer_store_dwordx4 v[12:15], v4, s[60:63], s10 offen offset:16 sc1
    s_mul_i32 s10, s2, 14336
    buffer_load_dwordx4 v[72:75], v2, s[52:55], s10 offen offset:0 nt
    buffer_load_dwordx4 v[76:79], v2, s[52:55], s10 offen offset:896 nt
    buffer_load_dwordx4 v[80:83], v2, s[52:55], s10 offen offset:1792 nt
    buffer_load_dwordx4 v[84:87], v2, s[52:55], s10 offen offset:2688 nt
    s_add_u32 s10, s10, 3584
    buffer_load_dwordx4 v[88:91], v2, s[52:55], s10 offen offset:0 nt
    buffer_load_dwordx4 v[92:95], v2, s[52:55], s10 offen offset:896 nt
    buffer_load_dwordx4 v[96:99], v2, s[52:55], s10 offen offset:1792 nt
    buffer_load_dwordx4 v[100:103], v2, s[52:55], s10 offen offset:2688 nt
    s_add_u32 s10, s10, 3584
    buffer_load_dwordx4 v[104:107], v2, s[52:55], s10 offen offset:0 nt
    buffer_load_dwordx4 v[108:111], v2, s[52:55], s10 offen offset:896 nt
    buffer_load_dwordx4 v[112:115], v2, s[52:55], s10 offen offset:1792 nt
    buffer_load_dwordx4 v[116:119], v2, s[52:55], s10 offen offset:2688 nt
    s_add_u32 s10, s10, 3584
    buffer_load_dwordx4 v[120:123], v2, s[52:55], s10 offen offset:0 nt
    buffer_load_dwordx4 v[124:127], v2, s[52:55], s10 offen offset:896 nt
    buffer_load_dwordx4 v[128:131], v2, s[52:55], s10 offen offset:1792 nt
    buffer_load_dwordx4 v[132:135], v2, s[52:55], s10 offen offset:2688 nt
    s_lshl_b32 s12, s2, 11
    s_add_u32 s12, s12, 3686400
    buffer_load_dwordx4 v[16:19], v2, s[60:63], s12 offen sc1
    buffer_load_dwordx4 v[20:23], v2, s[60:63], s12 offen offset:1024 sc1
    s_sleep 12
    buffer_load_dwordx4 v[24:27], v2, s[60:63], s12 offen sc1
    buffer_load_dwordx4 v[28:31], v2, s[60:63], s12 offen offset:1024 sc1
    s_mov_b32 s88, 0
L_g4:
    s_nop 1
    s_waitcnt vmcnt(2)
    v_cmp_ne_u64 vcc, s[64:65], v[18:19]
    s_mov_b64 s[4:5], vcc
    v_cmp_ne_u64 vcc, s[64:65], v[22:23]
    s_or_b64 s[4:5], s[4:5], vcc
    s_cmp_eq_u64 s[4:5], 0
    s_cbranch_scc1 L_g4_ok0
    buffer_load_dwordx4 v[16:19], v2, s[60:63], s12 offen sc1
    buffer_load_dwordx4 v[20:23], v2, s[60:63], s12 offen offset:1024 sc1
    s_waitcnt vmcnt(2)
    v_cmp_ne_u64 vcc, s[64:65], v[26:27]
    s_mov_b64 s[4:5], vcc
    v_cmp_ne_u64 vcc, s[64:65], v[30:31]
    s_or_b64 s[4:5], s[4:5], vcc
    s_cmp_eq_u64 s[4:5], 0
    s_cbranch_scc1 L_g4_ok1
    buffer_load_dwordx4 v[24:27], v2, s[60:63], s12 offen sc1
    buffer_load_dwordx4 v[28:31], v2, s[60:63], s12 offen offset:1024 sc1
    s_add_u32 s88, s88, 1
    s_cmp_lt_u32 s88, 20000
    s_cbranch_scc1 L_g4
L_g4_ok0:
    s_nop 1
    v_add_f32 v136, v16, v20
    v_add_f32 v137, v17, v21
    s_branch L_g4_done
L_g4_ok1:
    s_nop 1
    v_add_f32 v136, v24, v28
    v_add_f32 v137, v25, v29
L_g4_done:
    s_nop 1
    v_add_f32_dpp v136, v136, v136 row_ror:8 row_mask:0xf bank_mask:0xf
    v_add_f32_dpp v137, v137, v137 row_ror:8 row_mask:0xf bank_mask:0xf
    v_mov_b32 v144, v136
    v_mov_b32 v145, v137
    s_nop 0
    v_permlane16_swap_b32 v144, v136
    v_permlane16_swap_b32 v145, v137
    v_add_f32 v136, v136, v144
    v_add_f32 v137, v137, v145
    v_mov_b32 v144, v136
    v_mov_b32 v145, v137
    s_nop 0
    v_permlane32_swap_b32 v144, v136
    v_permlane32_swap_b32 v145, v137
    v_add_f32 v136, v136, v144
    v_add_f32 v137, v137, v145
    v_and_b32 v145, 0xffff0000, v163
    v_lshlrev_b32 v144, 16, v163
    v_cvt_pk_bf16_f32 v136, v136, v136
    v_lshlrev_b32 v136, 16, v136
    v_add_f32 v136, v136, v144
    v_cvt_pk_bf16_f32 v136, v136, v136
    v_lshlrev_b32 v136, 16, v136
    v_mul_f32 v146, v136, v136
    v_mul_f32 v146, v146, v136
    v_mul_f32 v146, 0x3d372713, v146
    v_add_f32 v146, v136, v146
    v_mul_f32 v146, 0x3f4c422a, v146
    v_mul_f32 v146, 0x4038aa3b, v146
    v_exp_f32 v146, v146
    s_nop 0
    v_add_f32 v146, 1.0, v146
    v_rcp_f32 v146, v146
    s_nop 0
    v_fma_f32 v146, -2.0, v146, 1.0
    v_add_f32 v146, 1.0, v146
    v_mul_f32 v136, 0.5, v136
    v_mul_f32 v136, v136, v146
    v_cvt_pk_bf16_f32 v137, v137, v137
    v_lshlrev_b32 v137, 16, v137
    v_add_f32 v137, v137, v145
    v_cvt_pk_bf16_f32 v137, v137, v137
    v_lshlrev_b32 v137, 16, v137
    v_mul_f32 v146, v137, v137
    v_mul_f32 v146, v146, v137
    v_mul_f32 v146, 0x3d372713, v146
    v_add_f32 v146, v137, v146
    v_mul_f32 v146, 0x3f4c422a, v146
    v_mul_f32 v146, 0x4038aa3b, v146
    v_exp_f32 v146, v146
    s_nop 0
    v_add_f32 v146, 1.0, v146
    v_rcp_f32 v146, v146
    s_nop 0
    v_fma_f32 v146, -2.0, v146, 1.0
    v_add_f32 v146, 1.0, v146
    v_mul_f32 v137, 0.5, v137
    v_mul_f32 v137, v137, v146
    v_cvt_pk_bf16_f32 v136, v136, v137
    s_nop 0
    v_readlane_b32 s80, v136, 0
    v_readlane_b32 s81, v136, 1
    v_readlane_b32 s82, v136, 2
    v_readlane_b32 s83, v136, 3
    v_readlane_b32 s84, v136, 4
    v_readlane_b32 s85, v136, 5
    v_readlane_b32 s86, v136, 6
    v_readlane_b32 s87, v136, 7
    s_add_u32 s10, s2, 256
    s_mul_i32 s10, s10, 3584
    s_add_u32 s10, s10, 2359296
    s_waitcnt vmcnt(0)
    v_mov_b32 v18, s64
    v_mov_b32 v19, s65
    v_mov_b32 v22, s64
    v_mov_b32 v23, s65
    v_mov_b32 v26, s64
    v_mov_b32 v27, s65
    v_mov_b32 v30, s64
    v_mov_b32 v31, s65
    v_perm_b32 v144, v76, v72, s72
    v_perm_b32 v76, v76, v72, s73
    v_mov_b32 v72, v144
    v_perm_b32 v144, v77, v73, s72
    v_perm_b32 v77, v77, v73, s73
    v_mov_b32 v73, v144
    v_perm_b32 v144, v78, v74, s72
    v_perm_b32 v78, v78, v74, s73
    v_mov_b32 v74, v144
    v_perm_b32 v144, v79, v75, s72
    v_perm_b32 v79, v79, v75, s73
    v_mov_b32 v75, v144
    v_perm_b32 v144, v84, v80, s72
    v_perm_b32 v84, v84, v80, s73
    v_mov_b32 v80, v144
    v_perm_b32 v144, v85, v81, s72
    v_perm_b32 v85, v85, v81, s73
    v_mov_b32 v81, v144
    v_perm_b32 v144, v86, v82, s72
    v_perm_b32 v86, v86, v82, s73
    v_mov_b32 v82, v144
    v_perm_b32 v144, v87, v83, s72
    v_perm_b32 v87, v87, v83, s73
    v_mov_b32 v83, v144
    v_perm_b32 v144, v92, v88, s72
    v_perm_b32 v92, v92, v88, s73
    v_mov_b32 v88, v144
    v_perm_b32 v144, v93, v89, s72
    v_perm_b32 v93, v93, v89, s73
    v_mov_b32 v89, v144
    v_perm_b32 v144, v94, v90, s72
    v_perm_b32 v94, v94, v90, s73
    v_mov_b32 v90, v144
    v_perm_b32 v144, v95, v91, s72
    v_perm_b32 v95, v95, v91, s73
    v_mov_b32 v91, v144
    v_perm_b32 v144, v100, v96, s72
    v_perm_b32 v100, v100, v96, s73
    v_mov_b32 v96, v144
    v_perm_b32 v144, v101, v97, s72
    v_perm_b32 v101, v101, v97, s73
    v_mov_b32 v97, v144
    v_perm_b32 v144, v102, v98, s72
    v_perm_b32 v102, v102, v98, s73
    v_mov_b32 v98, v144
    v_perm_b32 v144, v103, v99, s72
    v_perm_b32 v103, v103, v99, s73
    v_mov_b32 v99, v144
    v_perm_b32 v144, v108, v104, s72
    v_perm_b32 v108, v108, v104, s73
    v_mov_b32 v104, v144
    v_perm_b32 v144, v109, v105, s72
    v_perm_b32 v109, v109, v105, s73
    v_mov_b32 v105, v144
    v_perm_b32 v144, v110, v106, s72
    v_perm_b32 v110, v110, v106, s73
    v_mov_b32 v106, v144
    v_perm_b32 v144, v111, v107, s72
    v_perm_b32 v111, v111, v107, s73
    v_mov_b32 v107, v144
    v_perm_b32 v144, v116, v112, s72
    v_perm_b32 v116, v116, v112, s73
    v_mov_b32 v112, v144
    v_perm_b32 v144, v117, v113, s72
    v_perm_b32 v117, v117, v113, s73
    v_mov_b32 v113, v144
    v_perm_b32 v144, v118, v114, s72
    v_perm_b32 v118, v118, v114, s73
    v_mov_b32 v114, v144
    v_perm_b32 v144, v119, v115, s72
    v_perm_b32 v119, v119, v115, s73
    v_mov_b32 v115, v144
    v_perm_b32 v144, v124, v120, s72
    v_perm_b32 v124, v124, v120, s73
    v_mov_b32 v120, v144
    v_perm_b32 v144, v125, v121, s72
    v_perm_b32 v125, v125, v121, s73
    v_mov_b32 v121, v144
    v_perm_b32 v144, v126, v122, s72
    v_perm_b32 v126, v126, v122, s73
    v_mov_b32 v122, v144
    v_perm_b32 v144, v127, v123, s72
    v_perm_b32 v127, v127, v123, s73
    v_mov_b32 v123, v144
    v_perm_b32 v144, v132, v128, s72
    v_perm_b32 v132, v132, v128, s73
    v_mov_b32 v128, v144
    v_perm_b32 v144, v133, v129, s72
    v_perm_b32 v133, v133, v129, s73
    v_mov_b32 v129, v144
    v_perm_b32 v144, v134, v130, s72
    v_perm_b32 v134, v134, v130, s73
    v_mov_b32 v130, v144
    v_perm_b32 v144, v135, v131, s72
    v_perm_b32 v135, v135, v131, s73
    v_mov_b32 v131, v144
    v_dot2_f32_bf16 v16, v72, s80, 0
    v_dot2_f32_bf16 v17, v76, s80, 0
    v_dot2_f32_bf16 v20, v73, s80, 0
    v_dot2_f32_bf16 v21, v77, s80, 0
    v_dot2_f32_bf16 v24, v74, s80, 0
    v_dot2_f32_bf16 v25, v78, s80, 0
    v_dot2_f32_bf16 v28, v75, s80, 0
    v_dot2_f32_bf16 v29, v79, s80, 0
    v_dot2_f32_bf16 v16, v80, s81, v16
    v_dot2_f32_bf16 v17, v84, s81, v17
    v_dot2_f32_bf16 v20, v81, s81, v20
    v_dot2_f32_bf16 v21, v85, s81, v21
    v_dot2_f32_bf16 v24, v82, s81, v24
    v_dot2_f32_bf16 v25, v86, s81, v25
    v_dot2_f32_bf16 v28, v83, s81, v28
    v_dot2_f32_bf16 v29, v87, s81, v29
    v_dot2_f32_bf16 v16, v88, s82, v16
    v_dot2_f32_bf16 v17, v92, s82, v17
    v_dot2_f32_bf16 v20, v89, s82, v20
    v_dot2_f32_bf16 v21, v93, s82, v21
    v_dot2_f32_bf16 v24, v90, s82, v24
    v_dot2_f32_bf16 v25, v94, s82, v25
    v_dot2_f32_bf16 v28, v91, s82, v28
    v_dot2_f32_bf16 v29, v95, s82, v29
    v_dot2_f32_bf16 v16, v96, s83, v16
    v_dot2_f32_bf16 v17, v100, s83, v17
    v_dot2_f32_bf16 v20, v97, s83, v20
    v_dot2_f32_bf16 v21, v101, s83, v21
    v_dot2_f32_bf16 v24, v98, s83, v24
    v_dot2_f32_bf16 v25, v102, s83, v25
    v_dot2_f32_bf16 v28, v99, s83, v28
    v_dot2_f32_bf16 v29, v103, s83, v29
    v_dot2_f32_bf16 v16, v104, s84, v16
    v_dot2_f32_bf16 v17, v108, s84, v17
    v_dot2_f32_bf16 v20, v105, s84, v20
    v_dot2_f32_bf16 v21, v109, s84, v21
    v_dot2_f32_bf16 v24, v106, s84, v24
    v_dot2_f32_bf16 v25, v110, s84, v25
    v_dot2_f32_bf16 v28, v107, s84, v28
    v_dot2_f32_bf16 v29, v111, s84, v29
    v_dot2_f32_bf16 v16, v112, s85, v16
    v_dot2_f32_bf16 v17, v116, s85, v17
    v_dot2_f32_bf16 v20, v113, s85, v20
    v_dot2_f32_bf16 v21, v117, s85, v21
    v_dot2_f32_bf16 v24, v114, s85, v24
    v_dot2_f32_bf16 v25, v118, s85, v25
    v_dot2_f32_bf16 v28, v115, s85, v28
    v_dot2_f32_bf16 v29, v119, s85, v29
    v_dot2_f32_bf16 v16, v120, s86, v16
    v_dot2_f32_bf16 v17, v124, s86, v17
    v_dot2_f32_bf16 v20, v121, s86, v20
    v_dot2_f32_bf16 v21, v125, s86, v21
    v_dot2_f32_bf16 v24, v122, s86, v24
    v_dot2_f32_bf16 v25, v126, s86, v25
    v_dot2_f32_bf16 v28, v123, s86, v28
    v_dot2_f32_bf16 v29, v127, s86, v29
    v_dot2_f32_bf16 v16, v128, s87, v16
    v_dot2_f32_bf16 v17, v132, s87, v17
    v_dot2_f32_bf16 v20, v129, s87, v20
    v_dot2_f32_bf16 v21, v133, s87, v21
    v_dot2_f32_bf16 v24, v130, s87, v24
    v_dot2_f32_bf16 v25, v134, s87, v25
    v_dot2_f32_bf16 v28, v131, s87, v28
    v_dot2_f32_bf16 v29, v135, s87, v29
    v_lshlrev_b32 v2, 4, v1
    s_mov_b64 exec, s[74:75]
    buffer_store_dwordx4 v[16:19], v2, s[60:63], s10 offen offset:0 sc1
    buffer_store_dwordx4 v[20:23], v2, s[60:63], s10 offen offset:896 sc1
    buffer_store_dwordx4 v[24:27], v2, s[60:63], s10 offen offset:1792 sc1
    buffer_store_dwordx4 v[28:31], v2, s[60:63], s10 offen offset:2688 sc1
    s_mov_b64 exec, -1
L_end:
    s_endpgm
.section .rodata,"a"
.p2align 6
.amdhsa_kernel parallel_sum__sliding_block_cached__mixer_channel_mlp__decode_kernel
  .amdhsa_next_free_vgpr 168
  .amdhsa_next_free_sgpr 102
  .amdhsa_accum_offset 168
  .amdhsa_group_segment_fixed_size 0
  .amdhsa_kernarg_size 104
  .amdhsa_user_sgpr_count 2
  .amdhsa_user_sgpr_kernarg_segment_ptr 1
  .amdhsa_system_sgpr_workgroup_id_x 1
.end_amdhsa_kernel
```
